```python
import torch

def _softmax(x, axis=-1):
    return torch.softmax(x, dim=axis)
def _gelu(x):
    return torch.nn.functional.gelu(x, approximate="tanh")
def _silu(x):
    return torch.nn.functional.silu(x)
def _sigmoid(x):
    return torch.sigmoid(x)
def _layernorm(x, axis=-1, eps=1e-5):
    m = x.mean(dim=axis, keepdim=True)
    v = x.var(dim=axis, keepdim=True, unbiased=False)
    return (x - m) / torch.sqrt(v + eps)
def _scatter_add(tgt, idx, src, axis=0):
    return tgt.clone().index_add_(axis, idx, src)
def _segment_sum(src, seg, n):
    out = torch.zeros((n,) + src.shape[1:], dtype=src.dtype)
    return out.index_add_(0, seg, src)
def _pad(x, pw):
    flat = tuple(v for pair in reversed(pw) for v in pair)
    return torch.nn.functional.pad(x, flat)

kernel_name = 'standalone__gqa_block_cached__near_ridge'

def setup_inputs():

    _w = (lambda a: (lambda t: t.to(torch.bfloat16) if t.is_floating_point() else t)(torch.as_tensor(a)))
    B, Sq, D = 16, 64, 640
    Hq, Hkv, Sk, Dh = 32, 32, 64, 128
    assert Hq % Hkv == 0, (Hq, Hkv)
    return {
        "x": _w((lambda *s: torch.randn(*s, dtype=torch.bfloat16) * 0.8)(B, Sq, D)),
        "k_cache": _w((lambda *s: torch.randn(*s, dtype=torch.bfloat16) * 0.8)(B, Hkv, Sk, Dh)),
        "v_cache": _w((lambda *s: torch.randn(*s, dtype=torch.bfloat16) * 0.05)(B, Hkv, Sk, Dh)),
        "wq": _w((lambda *s: torch.randn(*s, dtype=torch.bfloat16) * 0.8)(D, Hq * Dh) * (D ** -0.5)),
        "wo": _w((lambda *s: torch.randn(*s, dtype=torch.bfloat16) * 0.05)(Hq * Dh, D) * ((Hq * Dh) ** -0.5)),
    }

def reference(x, k_cache, v_cache, wq, wo):
    B, Sq, D = x.shape
    Hq, Dh = 32, 128
    Hkv = k_cache.shape[1]
    rep = Hq // Hkv
    q = (lambda x, *d: x.permute(*d))((x @ wq).reshape(B, Sq, Hq, Dh), 0, 2, 1, 3)
    k = (lambda x, n, axis: torch.repeat_interleave(x, n, dim=axis))(k_cache, rep, axis=1)
    v = (lambda x, n, axis: torch.repeat_interleave(x, n, dim=axis))(v_cache, rep, axis=1)
    scores = torch.einsum("bhqd,bhkd->bhqk", q, k) * (Dh ** -0.5)
    p = _softmax(scores, axis=-1)
    o = torch.einsum("bhqk,bhkd->bhqd", p, v)
    return (lambda x, *d: x.permute(*d))(o, 0, 2, 1, 3).reshape(B, Sq, Hq * Dh) @ wo
```

```asm
; @launch grid=(256,1,1) block=(512,1,1) lds=163840
.amdgcn_target "amdgcn-amd-amdhsa--gfx950"
.text
.globl standalone__gqa_block_cached__near_ridge_kernel
.p2align 8
.type standalone__gqa_block_cached__near_ridge_kernel,@function
standalone__gqa_block_cached__near_ridge_kernel:
    s_cmp_ge_u32 s2, 256
    s_cbranch_scc1 K_END
    s_load_dwordx4 s[4:7], s[0:1], 0
    s_load_dwordx4 s[8:11], s[0:1], 16
    s_load_dwordx4 s[12:15], s[0:1], 32
    s_load_dwordx4 s[16:19], s[0:1], 48
    v_and_b32 v1, 63, v0
    v_lshrrev_b32 v2, 6, v0
    s_and_b32 s3, s2, 1
    s_lshl_b32 s3, s3, 2
    s_lshr_b32 s46, s2, 6
    s_add_u32 s46, s46, s3
    s_bfe_u32 s48, s2, 0x20001
    s_bfe_u32 s47, s2, 0x30003
    s_lshl_b32 s45, s48, 3
    s_add_u32 s45, s45, s47
    v_readfirstlane_b32 s44, v2
    s_nop 3
    s_getpc_b64 s[50:51]
K_PC:
    v_lshlrev_b32 v2, 6, v0
    v_min_u32 v2, K_CODE_END-K_PC-4, v2
    global_load_dword v43, v2, s[50:51]
    s_cmp_lt_u32 s44, 4
    s_cbranch_scc1 K_COMPUTE
    s_setprio 1
    s_sub_u32 s49, s44, 4
    v_lshrrev_b32 v21, 3, v1
    v_lshrrev_b32 v22, 4, v1
    v_and_b32 v23, 7, v1
    v_and_b32 v24, 15, v1
    s_lshl_b32 s50, s49, 5
    s_movk_i32 s51, 1280
    v_add_u32 v2, s50, v21
    v_mul_u32_u24 v2, s51, v2
    v_xor_b32 v3, v22, v23
    v_lshl_add_u32 v8, v3, 4, v2
    v_xor_b32 v2, 64, v8
    v_add_u32 v9, 9216, v2
    v_add_u32 v10, 18432, v8
    v_add_u32 v11, 18432, v9
    s_lshl_b32 s50, s49, 4
    v_lshlrev_b32 v4, 2, v22
    v_xor_b32 v4, v4, v24
    v_lshlrev_b32 v4, 4, v4
    v_add_u32 v2, s50, v22
    v_lshl_add_u32 v12, v2, 13, v4
    v_add_u32 v13, 31744, v12
    v_add_u32 v14, 63488, v12
    v_add_u32 v15, 95232, v12
    s_mul_i32 s52, s46, 163840
    s_lshl_b32 s53, s45, 8
    s_lshl_b32 s55, s49, 12
    s_waitcnt lgkmcnt(0)
    s_mov_b32 s20, s4
    s_mov_b32 s21, s5
    s_mov_b32 s22, 1310720
    s_mov_b32 s23, 0x20000
    s_mov_b32 s24, s10
    s_mov_b32 s25, s11
    s_mov_b32 s26, 5242880
    s_mov_b32 s27, 0x20000
    s_add_u32 m0, s55, 0
    s_add_u32 s57, s52, 0
    buffer_load_dwordx4 v8, s[20:23], s57 offen offset:0 lds
    buffer_load_dwordx4 v9, s[20:23], s57 offen offset:1024 lds
    buffer_load_dwordx4 v10, s[20:23], s57 offen offset:2048 lds
    buffer_load_dwordx4 v11, s[20:23], s57 offen offset:3072 lds
    s_add_u32 m0, s55, 49152
    s_add_u32 s58, s53, 0
    buffer_load_dwordx4 v12, s[24:27], s58 offen offset:0 lds
    buffer_load_dwordx4 v13, s[24:27], s58 offen offset:1024 lds
    buffer_load_dwordx4 v14, s[24:27], s58 offen offset:2048 lds
    buffer_load_dwordx4 v15, s[24:27], s58 offen offset:3072 lds
    s_add_u32 m0, s55, 16384
    s_add_u32 s57, s52, 128
    buffer_load_dwordx4 v8, s[20:23], s57 offen offset:0 lds
    buffer_load_dwordx4 v9, s[20:23], s57 offen offset:1024 lds
    buffer_load_dwordx4 v10, s[20:23], s57 offen offset:2048 lds
    buffer_load_dwordx4 v11, s[20:23], s57 offen offset:3072 lds
    s_add_u32 m0, s55, 65536
    s_add_u32 s58, s53, 524288
    buffer_load_dwordx4 v12, s[24:27], s58 offen offset:0 lds
    buffer_load_dwordx4 v13, s[24:27], s58 offen offset:1024 lds
    buffer_load_dwordx4 v14, s[24:27], s58 offen offset:2048 lds
    buffer_load_dwordx4 v15, s[24:27], s58 offen offset:3072 lds
    s_mov_b32 s28, s6
    s_mov_b32 s29, s7
    s_mov_b32 s30, 8388608
    s_mov_b32 s31, 0x20000
    s_mov_b32 s32, s8
    s_mov_b32 s33, s9
    s_mov_b32 s34, 8388608
    s_mov_b32 s35, 0x20000
    s_mov_b32 s36, s12
    s_mov_b32 s37, s13
    s_mov_b32 s38, 5242880
    s_mov_b32 s39, 0x20000
    s_lshr_b32 s3, s49, 1
    s_lshl_b32 s50, s46, 1
    s_add_u32 s50, s50, s3
    s_lshl_b32 s50, s50, 5
    s_add_u32 s50, s50, s45
    s_lshl_b32 s50, s50, 14
    s_and_b32 s3, s49, 1
    s_lshl_b32 s3, s3, 13
    s_add_u32 s54, s50, s3
    s_lshl_b32 s56, s49, 13
    v_lshlrev_b32 v2, 8, v22
    v_add_u32 v20, v2, v4
    v_add_u32 v3, 0, v22
    v_xor_b32 v3, v3, v24
    v_lshl_add_u32 v16, v3, 4, v2
    v_add_u32 v3, 4, v22
    v_xor_b32 v3, v3, v24
    v_lshl_add_u32 v17, v3, 4, v2
    v_add_u32 v3, 8, v22
    v_xor_b32 v3, v3, v24
    v_lshl_add_u32 v18, v3, 4, v2
    v_add_u32 v3, 12, v22
    v_xor_b32 v3, v3, v24
    v_lshl_add_u32 v19, v3, 4, v2
    s_movk_i32 s3, 6554
    v_add_u32 v2, 0, v1
    v_mul_u32_u24 v3, s3, v2
    v_lshrrev_b32 v3, 16, v3
    v_mul_u32_u24 v4, 10, v3
    v_sub_u32 v2, v2, v4
    v_and_b32 v4, 0x13, v3
    v_bfe_u32 v5, v3, 2, 1
    v_lshl_or_b32 v4, v5, 3, v4
    v_bfe_u32 v5, v3, 3, 1
    v_lshl_or_b32 v4, v5, 2, v4
    v_mul_u32_u24 v4, s51, v4
    v_lshl_add_u32 v2, v2, 4, v4
    v_mov_b32 v27, v2
    v_add_u32 v2, 64, v1
    v_mul_u32_u24 v3, s3, v2
    v_lshrrev_b32 v3, 16, v3
    v_mul_u32_u24 v4, 10, v3
    v_sub_u32 v2, v2, v4
    v_and_b32 v4, 0x13, v3
    v_bfe_u32 v5, v3, 2, 1
    v_lshl_or_b32 v4, v5, 3, v4
    v_bfe_u32 v5, v3, 3, 1
    v_lshl_or_b32 v4, v5, 2, v4
    v_mul_u32_u24 v4, s51, v4
    v_lshl_add_u32 v2, v2, 4, v4
    v_subrev_u32 v28, 1024, v2
    v_add_u32 v2, 128, v1
    v_mul_u32_u24 v3, s3, v2
    v_lshrrev_b32 v3, 16, v3
    v_mul_u32_u24 v4, 10, v3
    v_sub_u32 v2, v2, v4
    v_and_b32 v4, 0x13, v3
    v_bfe_u32 v5, v3, 2, 1
    v_lshl_or_b32 v4, v5, 3, v4
    v_bfe_u32 v5, v3, 3, 1
    v_lshl_or_b32 v4, v5, 2, v4
    v_mul_u32_u24 v4, s51, v4
    v_lshl_add_u32 v2, v2, 4, v4
    v_subrev_u32 v29, 2048, v2
    v_add_u32 v2, 192, v1
    v_mul_u32_u24 v3, s3, v2
    v_lshrrev_b32 v3, 16, v3
    v_mul_u32_u24 v4, 10, v3
    v_sub_u32 v2, v2, v4
    v_and_b32 v4, 0x13, v3
    v_bfe_u32 v5, v3, 2, 1
    v_lshl_or_b32 v4, v5, 3, v4
    v_bfe_u32 v5, v3, 3, 1
    v_lshl_or_b32 v4, v5, 2, v4
    v_mul_u32_u24 v4, s51, v4
    v_lshl_add_u32 v2, v2, 4, v4
    v_subrev_u32 v30, 3072, v2
    v_add_u32 v2, 256, v1
    v_mul_u32_u24 v3, s3, v2
    v_lshrrev_b32 v3, 16, v3
    v_mul_u32_u24 v4, 10, v3
    v_sub_u32 v2, v2, v4
    v_and_b32 v4, 0x13, v3
    v_bfe_u32 v5, v3, 2, 1
    v_lshl_or_b32 v4, v5, 3, v4
    v_bfe_u32 v5, v3, 3, 1
    v_lshl_or_b32 v4, v5, 2, v4
    v_mul_u32_u24 v4, s51, v4
    v_lshl_add_u32 v2, v2, 4, v4
    v_mov_b32 v31, v2
    s_mul_i32 s59, s47, 160
    s_mul_i32 s3, s49, 40960
    s_add_u32 s59, s59, s3
    s_mul_i32 s50, s49, 5120
    s_waitcnt vmcnt(8)
    s_barrier
    s_add_u32 m0, s55, 32768
    s_add_u32 s57, s52, 256
    buffer_load_dwordx4 v8, s[20:23], s57 offen offset:0 lds
    buffer_load_dwordx4 v9, s[20:23], s57 offen offset:1024 lds
    buffer_load_dwordx4 v10, s[20:23], s57 offen offset:2048 lds
    buffer_load_dwordx4 v11, s[20:23], s57 offen offset:3072 lds
    s_add_u32 m0, s55, 81920
    s_add_u32 s58, s53, 1048576
    buffer_load_dwordx4 v12, s[24:27], s58 offen offset:0 lds
    buffer_load_dwordx4 v13, s[24:27], s58 offen offset:1024 lds
    buffer_load_dwordx4 v14, s[24:27], s58 offen offset:2048 lds
    buffer_load_dwordx4 v15, s[24:27], s58 offen offset:3072 lds
    s_waitcnt vmcnt(8)
    s_barrier
    s_add_u32 m0, s55, 0
    s_add_u32 s57, s52, 384
    buffer_load_dwordx4 v8, s[20:23], s57 offen offset:0 lds
    buffer_load_dwordx4 v9, s[20:23], s57 offen offset:1024 lds
    buffer_load_dwordx4 v10, s[20:23], s57 offen offset:2048 lds
    buffer_load_dwordx4 v11, s[20:23], s57 offen offset:3072 lds
    s_add_u32 m0, s55, 49152
    s_add_u32 s58, s53, 1572864
    buffer_load_dwordx4 v12, s[24:27], s58 offen offset:0 lds
    buffer_load_dwordx4 v13, s[24:27], s58 offen offset:1024 lds
    buffer_load_dwordx4 v14, s[24:27], s58 offen offset:2048 lds
    buffer_load_dwordx4 v15, s[24:27], s58 offen offset:3072 lds
    s_add_u32 m0, s56, 98304
    s_add_u32 s57, s54, 0
    buffer_load_dwordx4 v16, s[28:31], s57 offen offset:0 nt lds
    buffer_load_dwordx4 v17, s[28:31], s57 offen offset:1024 nt lds
    s_waitcnt vmcnt(10)
    s_barrier
    s_add_u32 m0, s55, 16384
    s_add_u32 s57, s52, 512
    buffer_load_dwordx4 v8, s[20:23], s57 offen offset:0 lds
    buffer_load_dwordx4 v9, s[20:23], s57 offen offset:1024 lds
    buffer_load_dwordx4 v10, s[20:23], s57 offen offset:2048 lds
    buffer_load_dwordx4 v11, s[20:23], s57 offen offset:3072 lds
    s_add_u32 m0, s55, 65536
    s_add_u32 s58, s53, 2097152
    buffer_load_dwordx4 v12, s[24:27], s58 offen offset:0 lds
    buffer_load_dwordx4 v13, s[24:27], s58 offen offset:1024 lds
    buffer_load_dwordx4 v14, s[24:27], s58 offen offset:2048 lds
    buffer_load_dwordx4 v15, s[24:27], s58 offen offset:3072 lds
    s_add_u32 m0, s56, 98304
    s_add_u32 s57, s54, 0
    buffer_load_dwordx4 v18, s[28:31], s57 offen offset:2048 nt lds
    buffer_load_dwordx4 v19, s[28:31], s57 offen offset:3072 nt lds
    s_waitcnt vmcnt(12)
    s_barrier
    s_add_u32 m0, s55, 32768
    s_add_u32 s57, s52, 640
    buffer_load_dwordx4 v8, s[20:23], s57 offen offset:0 lds
    buffer_load_dwordx4 v9, s[20:23], s57 offen offset:1024 lds
    buffer_load_dwordx4 v10, s[20:23], s57 offen offset:2048 lds
    buffer_load_dwordx4 v11, s[20:23], s57 offen offset:3072 lds
    s_add_u32 m0, s55, 81920
    s_add_u32 s58, s53, 2621440
    buffer_load_dwordx4 v12, s[24:27], s58 offen offset:0 lds
    buffer_load_dwordx4 v13, s[24:27], s58 offen offset:1024 lds
    buffer_load_dwordx4 v14, s[24:27], s58 offen offset:2048 lds
    buffer_load_dwordx4 v15, s[24:27], s58 offen offset:3072 lds
    s_add_u32 m0, s56, 102400
    s_add_u32 s57, s54, 4096
    buffer_load_dwordx4 v16, s[28:31], s57 offen offset:0 nt lds
    buffer_load_dwordx4 v17, s[28:31], s57 offen offset:1024 nt lds
    s_waitcnt vmcnt(12)
    s_barrier
    s_add_u32 m0, s55, 0
    s_add_u32 s57, s52, 768
    buffer_load_dwordx4 v8, s[20:23], s57 offen offset:0 lds
    buffer_load_dwordx4 v9, s[20:23], s57 offen offset:1024 lds
    buffer_load_dwordx4 v10, s[20:23], s57 offen offset:2048 lds
    buffer_load_dwordx4 v11, s[20:23], s57 offen offset:3072 lds
    s_add_u32 m0, s55, 49152
    s_add_u32 s58, s53, 3145728
    buffer_load_dwordx4 v12, s[24:27], s58 offen offset:0 lds
    buffer_load_dwordx4 v13, s[24:27], s58 offen offset:1024 lds
    buffer_load_dwordx4 v14, s[24:27], s58 offen offset:2048 lds
    buffer_load_dwordx4 v15, s[24:27], s58 offen offset:3072 lds
    s_add_u32 m0, s56, 102400
    s_add_u32 s57, s54, 4096
    buffer_load_dwordx4 v18, s[28:31], s57 offen offset:2048 nt lds
    buffer_load_dwordx4 v19, s[28:31], s57 offen offset:3072 nt lds
    s_waitcnt vmcnt(12)
    s_barrier
    s_add_u32 m0, s55, 16384
    s_add_u32 s57, s52, 896
    buffer_load_dwordx4 v8, s[20:23], s57 offen offset:0 lds
    buffer_load_dwordx4 v9, s[20:23], s57 offen offset:1024 lds
    buffer_load_dwordx4 v10, s[20:23], s57 offen offset:2048 lds
    buffer_load_dwordx4 v11, s[20:23], s57 offen offset:3072 lds
    s_add_u32 m0, s55, 65536
    s_add_u32 s58, s53, 3670016
    buffer_load_dwordx4 v12, s[24:27], s58 offen offset:0 lds
    buffer_load_dwordx4 v13, s[24:27], s58 offen offset:1024 lds
    buffer_load_dwordx4 v14, s[24:27], s58 offen offset:2048 lds
    buffer_load_dwordx4 v15, s[24:27], s58 offen offset:3072 lds
    s_waitcnt vmcnt(10)
    s_barrier
    s_add_u32 m0, s55, 32768
    s_add_u32 s57, s52, 1024
    buffer_load_dwordx4 v8, s[20:23], s57 offen offset:0 lds
    buffer_load_dwordx4 v9, s[20:23], s57 offen offset:1024 lds
    buffer_load_dwordx4 v10, s[20:23], s57 offen offset:2048 lds
    buffer_load_dwordx4 v11, s[20:23], s57 offen offset:3072 lds
    s_add_u32 m0, s55, 81920
    s_add_u32 s58, s53, 4194304
    buffer_load_dwordx4 v12, s[24:27], s58 offen offset:0 lds
    buffer_load_dwordx4 v13, s[24:27], s58 offen offset:1024 lds
    buffer_load_dwordx4 v14, s[24:27], s58 offen offset:2048 lds
    buffer_load_dwordx4 v15, s[24:27], s58 offen offset:3072 lds
    s_waitcnt vmcnt(8)
    s_barrier
    s_add_u32 m0, s55, 0
    s_add_u32 s57, s52, 1152
    buffer_load_dwordx4 v8, s[20:23], s57 offen offset:0 lds
    buffer_load_dwordx4 v9, s[20:23], s57 offen offset:1024 lds
    buffer_load_dwordx4 v10, s[20:23], s57 offen offset:2048 lds
    buffer_load_dwordx4 v11, s[20:23], s57 offen offset:3072 lds
    s_add_u32 m0, s55, 49152
    s_add_u32 s58, s53, 4718592
    buffer_load_dwordx4 v12, s[24:27], s58 offen offset:0 lds
    buffer_load_dwordx4 v13, s[24:27], s58 offen offset:1024 lds
    buffer_load_dwordx4 v14, s[24:27], s58 offen offset:2048 lds
    buffer_load_dwordx4 v15, s[24:27], s58 offen offset:3072 lds
    s_add_u32 m0, s56, 131072
    s_add_u32 s57, s54, 0
    buffer_load_dwordx4 v20, s[32:35], s57 offen offset:0 nt lds
    buffer_load_dwordx4 v20, s[32:35], s57 offen offset:1024 nt lds
    buffer_load_dwordx4 v20, s[32:35], s57 offen offset:2048 nt lds
    buffer_load_dwordx4 v20, s[32:35], s57 offen offset:3072 nt lds
    s_waitcnt vmcnt(12)
    s_barrier
    s_add_u32 m0, s56, 135168
    s_add_u32 s57, s54, 4096
    buffer_load_dwordx4 v20, s[32:35], s57 offen offset:0 nt lds
    buffer_load_dwordx4 v20, s[32:35], s57 offen offset:1024 nt lds
    buffer_load_dwordx4 v20, s[32:35], s57 offen offset:2048 nt lds
    buffer_load_dwordx4 v20, s[32:35], s57 offen offset:3072 nt lds
    s_waitcnt vmcnt(8)
    s_barrier
    s_lshr_b32 s3, s2, 3
    s_mul_i32 s3, s3, 40960
    s_mul_i32 s57, s48, 1310720
    s_add_u32 s57, s57, s3
    s_lshl_b32 s3, s49, 13
    s_add_u32 s58, s57, s3
    v_lshlrev_b32 v2, 7, v1
    buffer_load_dword v3, v2, s[36:39], s58 offen
    s_add_u32 s57, s57, 32768
    s_cmp_eq_u32 s49, 0
    s_cselect_b32 s58, s57, s58
    buffer_load_dword v3, v2, s[36:39], s58 offen
    s_waitcnt vmcnt(34)
    s_barrier
    s_waitcnt vmcnt(2)
    s_barrier
    s_add_u32 s3, s47, 0
    s_and_b32 s3, s3, 7
    s_lshl_b32 s61, s48, 3
    s_add_u32 s3, s3, s61
    s_mul_i32 s61, s3, 163840
    s_add_u32 m0, s50, 0
    s_add_u32 s57, s61, s59
    buffer_load_dwordx4 v27, s[36:39], s57 offen offset:0 lds
    buffer_load_dwordx4 v28, s[36:39], s57 offen offset:1024 lds
    buffer_load_dwordx4 v29, s[36:39], s57 offen offset:2048 lds
    buffer_load_dwordx4 v30, s[36:39], s57 offen offset:3072 lds
    s_add_u32 m0, s50, 4096
    s_nop 0
    buffer_load_dwordx4 v31, s[36:39], s57 offen lds
    s_add_u32 s3, s47, 1
    s_and_b32 s3, s3, 7
    s_lshl_b32 s61, s48, 3
    s_add_u32 s3, s3, s61
    s_mul_i32 s61, s3, 163840
    s_add_u32 m0, s50, 20480
    s_add_u32 s57, s61, s59
    buffer_load_dwordx4 v27, s[36:39], s57 offen offset:0 lds
    buffer_load_dwordx4 v28, s[36:39], s57 offen offset:1024 lds
    buffer_load_dwordx4 v29, s[36:39], s57 offen offset:2048 lds
    buffer_load_dwordx4 v30, s[36:39], s57 offen offset:3072 lds
    s_add_u32 m0, s50, 24576
    s_nop 0
    buffer_load_dwordx4 v31, s[36:39], s57 offen lds
    s_add_u32 s3, s47, 2
    s_and_b32 s3, s3, 7
    s_lshl_b32 s61, s48, 3
    s_add_u32 s3, s3, s61
    s_mul_i32 s61, s3, 163840
    s_add_u32 m0, s50, 40960
    s_add_u32 s57, s61, s59
    buffer_load_dwordx4 v27, s[36:39], s57 offen offset:0 lds
    buffer_load_dwordx4 v28, s[36:39], s57 offen offset:1024 lds
    buffer_load_dwordx4 v29, s[36:39], s57 offen offset:2048 lds
    buffer_load_dwordx4 v30, s[36:39], s57 offen offset:3072 lds
    s_add_u32 m0, s50, 45056
    s_nop 0
    buffer_load_dwordx4 v31, s[36:39], s57 offen lds
    s_barrier
    s_add_u32 s3, s47, 3
    s_and_b32 s3, s3, 7
    s_lshl_b32 s61, s48, 3
    s_add_u32 s3, s3, s61
    s_mul_i32 s61, s3, 163840
    s_add_u32 m0, s50, 61440
    s_add_u32 s57, s61, s59
    buffer_load_dwordx4 v27, s[36:39], s57 offen offset:0 lds
    buffer_load_dwordx4 v28, s[36:39], s57 offen offset:1024 lds
    buffer_load_dwordx4 v29, s[36:39], s57 offen offset:2048 lds
    buffer_load_dwordx4 v30, s[36:39], s57 offen offset:3072 lds
    s_add_u32 m0, s50, 65536
    s_nop 0
    buffer_load_dwordx4 v31, s[36:39], s57 offen lds
    s_add_u32 s3, s47, 4
    s_and_b32 s3, s3, 7
    s_lshl_b32 s61, s48, 3
    s_add_u32 s3, s3, s61
    s_mul_i32 s61, s3, 163840
    s_add_u32 m0, s50, 81920
    s_add_u32 s57, s61, s59
    buffer_load_dwordx4 v27, s[36:39], s57 offen offset:0 lds
    buffer_load_dwordx4 v28, s[36:39], s57 offen offset:1024 lds
    buffer_load_dwordx4 v29, s[36:39], s57 offen offset:2048 lds
    buffer_load_dwordx4 v30, s[36:39], s57 offen offset:3072 lds
    s_add_u32 m0, s50, 86016
    s_nop 0
    buffer_load_dwordx4 v31, s[36:39], s57 offen lds
    s_add_u32 s3, s47, 5
    s_and_b32 s3, s3, 7
    s_lshl_b32 s61, s48, 3
    s_add_u32 s3, s3, s61
    s_mul_i32 s61, s3, 163840
    s_add_u32 m0, s50, 102400
    s_add_u32 s57, s61, s59
    buffer_load_dwordx4 v27, s[36:39], s57 offen offset:0 lds
    buffer_load_dwordx4 v28, s[36:39], s57 offen offset:1024 lds
    buffer_load_dwordx4 v29, s[36:39], s57 offen offset:2048 lds
    buffer_load_dwordx4 v30, s[36:39], s57 offen offset:3072 lds
    s_add_u32 m0, s50, 106496
    s_nop 0
    buffer_load_dwordx4 v31, s[36:39], s57 offen lds
    s_add_u32 s3, s47, 6
    s_and_b32 s3, s3, 7
    s_lshl_b32 s61, s48, 3
    s_add_u32 s3, s3, s61
    s_mul_i32 s61, s3, 163840
    s_add_u32 m0, s50, 122880
    s_add_u32 s57, s61, s59
    buffer_load_dwordx4 v27, s[36:39], s57 offen offset:0 lds
    buffer_load_dwordx4 v28, s[36:39], s57 offen offset:1024 lds
    buffer_load_dwordx4 v29, s[36:39], s57 offen offset:2048 lds
    buffer_load_dwordx4 v30, s[36:39], s57 offen offset:3072 lds
    s_add_u32 m0, s50, 126976
    s_nop 0
    buffer_load_dwordx4 v31, s[36:39], s57 offen lds
    s_add_u32 s3, s47, 7
    s_and_b32 s3, s3, 7
    s_lshl_b32 s61, s48, 3
    s_add_u32 s3, s3, s61
    s_mul_i32 s61, s3, 163840
    s_add_u32 m0, s50, 143360
    s_add_u32 s57, s61, s59
    buffer_load_dwordx4 v27, s[36:39], s57 offen offset:0 lds
    buffer_load_dwordx4 v28, s[36:39], s57 offen offset:1024 lds
    buffer_load_dwordx4 v29, s[36:39], s57 offen offset:2048 lds
    buffer_load_dwordx4 v30, s[36:39], s57 offen offset:3072 lds
    s_add_u32 m0, s50, 147456
    s_nop 0
    buffer_load_dwordx4 v31, s[36:39], s57 offen lds
    s_waitcnt vmcnt(0)
    s_barrier
K_END:
    s_endpgm
K_COMPUTE:
    s_waitcnt lgkmcnt(0)
    s_mov_b32 s20, s18
    s_mov_b32 s21, s19
    s_mov_b32 s22, 18939904
    s_mov_b32 s23, 0x20000
    s_mov_b32 s24, s14
    s_mov_b32 s25, s15
    s_mov_b32 s26, 1310720
    s_mov_b32 s27, 0x20000
    s_mov_b32 s28, s16
    s_mov_b32 s29, s17
    s_mov_b32 s30, 256
    s_mov_b32 s31, 0x20000
    v_mov_b32 v5, 248
    s_or_b32 s3, s2, s44
    s_cmp_lg_u32 s3, 0
    s_cbranch_scc1 C_NONCE_RD
    s_memrealtime s[86:87]
    s_waitcnt lgkmcnt(0)
    s_or_b32 s86, s86, 1
    v_mov_b32 v6, s86
    v_mov_b32 v7, s87
    s_mov_b64 exec, 1
    buffer_store_dwordx2 v[6:7], v5, s[28:31], 0 offen sc1
    s_mov_b64 exec, -1
C_NONCE_RD:
    v_lshrrev_b32 v30, 5, v1
    v_and_b32 v31, 31, v1
    v_and_b32 v35, 15, v1
    s_lshl_b32 s50, s44, 5
    v_add_u32 v2, s50, v31
    v_lshrrev_b32 v3, 1, v2
    v_and_b32 v3, 7, v3
    v_xor_b32 v3, v3, v30
    v_lshlrev_b32 v3, 4, v3
    v_lshl_add_u32 v8, v2, 7, v3
    v_xor_b32 v9, 32, v8
    v_xor_b32 v10, 64, v8
    v_xor_b32 v11, 96, v8
    v_bfe_u32 v32, v1, 2, 2
    v_and_b32 v33, 3, v1
    v_bfe_u32 v34, v1, 4, 1
    v_and_b32 v2, 1, v33
    v_lshlrev_b32 v2, 1, v2
    v_lshrrev_b32 v3, 1, v33
    v_or_b32 v2, v2, v3
    v_lshlrev_b32 v2, 3, v2
    v_lshl_add_u32 v2, v34, 5, v2
    v_lshl_add_u32 v3, v30, 3, v32
    v_lshl_add_u32 v2, v3, 8, v2
    s_lshr_b32 s3, s44, 1
    s_lshl_b32 s3, s3, 14
    s_add_u32 s51, s3, 131072
    s_add_u32 s52, s3, 98304
    v_xor_b32 v3, 0, v32
    v_lshl_add_u32 v3, v3, 6, v2
    v_add_u32 v12, 49152, v3
    v_add_u32 v26, s51, v3
    v_xor_b32 v3, 1, v32
    v_lshl_add_u32 v3, v3, 6, v2
    v_add_u32 v13, 49152, v3
    v_add_u32 v27, s51, v3
    v_xor_b32 v3, 2, v32
    v_lshl_add_u32 v3, v3, 6, v2
    v_add_u32 v14, 49152, v3
    v_add_u32 v28, s51, v3
    v_xor_b32 v3, 3, v32
    v_lshl_add_u32 v3, v3, 6, v2
    v_add_u32 v15, 49152, v3
    v_add_u32 v29, s51, v3
    v_and_b32 v2, 0x13, v31
    v_and_b32 v3, 4, v31
    v_lshl_or_b32 v2, v3, 1, v2
    v_bfe_u32 v3, v31, 3, 1
    v_lshl_or_b32 v2, v3, 2, v2
    v_and_b32 v3, 15, v2
    v_xor_b32 v3, v3, v30
    v_lshlrev_b32 v3, 4, v3
    v_lshl_add_u32 v2, v2, 8, v3
    v_add_u32 v24, s52, v2
    v_mov_b32 v16, v8
    v_mov_b32 v20, v12
    v_mov_b32 v17, v9
    v_mov_b32 v21, v13
    v_mov_b32 v18, v10
    v_mov_b32 v22, v14
    v_mov_b32 v19, v11
    v_mov_b32 v23, v15
    v_mov_b32 v64, 0
    v_mov_b32 v65, 0
    v_mov_b32 v66, 0
    v_mov_b32 v67, 0
    v_mov_b32 v68, 0
    v_mov_b32 v69, 0
    v_mov_b32 v70, 0
    v_mov_b32 v71, 0
    v_mov_b32 v72, 0
    v_mov_b32 v73, 0
    v_mov_b32 v74, 0
    v_mov_b32 v75, 0
    v_mov_b32 v76, 0
    v_mov_b32 v77, 0
    v_mov_b32 v78, 0
    v_mov_b32 v79, 0
    v_mov_b32 v80, 0
    v_mov_b32 v81, 0
    v_mov_b32 v82, 0
    v_mov_b32 v83, 0
    v_mov_b32 v84, 0
    v_mov_b32 v85, 0
    v_mov_b32 v86, 0
    v_mov_b32 v87, 0
    v_mov_b32 v88, 0
    v_mov_b32 v89, 0
    v_mov_b32 v90, 0
    v_mov_b32 v91, 0
    v_mov_b32 v92, 0
    v_mov_b32 v93, 0
    v_mov_b32 v94, 0
    v_mov_b32 v95, 0
    v_mov_b32 v96, 0
    v_mov_b32 v97, 0
    v_mov_b32 v98, 0
    v_mov_b32 v99, 0
    v_mov_b32 v100, 0
    v_mov_b32 v101, 0
    v_mov_b32 v102, 0
    v_mov_b32 v103, 0
    v_mov_b32 v104, 0
    v_mov_b32 v105, 0
    v_mov_b32 v106, 0
    v_mov_b32 v107, 0
    v_mov_b32 v108, 0
    v_mov_b32 v109, 0
    v_mov_b32 v110, 0
    v_mov_b32 v111, 0
    v_mov_b32 v112, 0
    v_mov_b32 v113, 0
    v_mov_b32 v114, 0
    v_mov_b32 v115, 0
    v_mov_b32 v116, 0
    v_mov_b32 v117, 0
    v_mov_b32 v118, 0
    v_mov_b32 v119, 0
    v_mov_b32 v120, 0
    v_mov_b32 v121, 0
    v_mov_b32 v122, 0
    v_mov_b32 v123, 0
    v_mov_b32 v124, 0
    v_mov_b32 v125, 0
    v_mov_b32 v126, 0
    v_mov_b32 v127, 0
    s_mov_b32 s53, 0
    s_mov_b32 s54, 9
    s_barrier
    ds_read_b128 v[160:163], v16
    ds_read_b64_tr_b16 v[128:129], v20 offset:0
    ds_read_b64_tr_b16 v[130:131], v20 offset:1024
    ds_read_b64_tr_b16 v[132:133], v21 offset:0
    ds_read_b64_tr_b16 v[134:135], v21 offset:1024
    ds_read_b64_tr_b16 v[136:137], v22 offset:0
    ds_read_b64_tr_b16 v[138:139], v22 offset:1024
    ds_read_b64_tr_b16 v[140:141], v23 offset:0
    ds_read_b64_tr_b16 v[142:143], v23 offset:1024
P1_LOOP:
    s_waitcnt lgkmcnt(6)
    v_mfma_f32_32x32x16_bf16 v[64:79], v[128:131], v[160:163], v[64:79]
    ds_read_b128 v[164:167], v17
    ds_read_b64_tr_b16 v[144:145], v20 offset:4096
    ds_read_b64_tr_b16 v[146:147], v20 offset:5120
    s_waitcnt lgkmcnt(7)
    v_mfma_f32_32x32x16_bf16 v[80:95], v[132:135], v[160:163], v[80:95]
    ds_read_b64_tr_b16 v[148:149], v21 offset:4096
    ds_read_b64_tr_b16 v[150:151], v21 offset:5120
    ds_read_b64_tr_b16 v[152:153], v22 offset:4096
    s_waitcnt lgkmcnt(8)
    v_mfma_f32_32x32x16_bf16 v[96:111], v[136:139], v[160:163], v[96:111]
    ds_read_b64_tr_b16 v[154:155], v22 offset:5120
    ds_read_b64_tr_b16 v[156:157], v23 offset:4096
    ds_read_b64_tr_b16 v[158:159], v23 offset:5120
    s_waitcnt lgkmcnt(9)
    v_mfma_f32_32x32x16_bf16 v[112:127], v[140:143], v[160:163], v[112:127]
    s_waitcnt lgkmcnt(6)
    v_mfma_f32_32x32x16_bf16 v[64:79], v[144:147], v[164:167], v[64:79]
    ds_read_b128 v[160:163], v18
    ds_read_b64_tr_b16 v[128:129], v20 offset:8192
    ds_read_b64_tr_b16 v[130:131], v20 offset:9216
    s_waitcnt lgkmcnt(7)
    v_mfma_f32_32x32x16_bf16 v[80:95], v[148:151], v[164:167], v[80:95]
    ds_read_b64_tr_b16 v[132:133], v21 offset:8192
    ds_read_b64_tr_b16 v[134:135], v21 offset:9216
    ds_read_b64_tr_b16 v[136:137], v22 offset:8192
    s_waitcnt lgkmcnt(8)
    v_mfma_f32_32x32x16_bf16 v[96:111], v[152:155], v[164:167], v[96:111]
    ds_read_b64_tr_b16 v[138:139], v22 offset:9216
    ds_read_b64_tr_b16 v[140:141], v23 offset:8192
    ds_read_b64_tr_b16 v[142:143], v23 offset:9216
    s_waitcnt lgkmcnt(9)
    v_mfma_f32_32x32x16_bf16 v[112:127], v[156:159], v[164:167], v[112:127]
    s_waitcnt lgkmcnt(6)
    v_mfma_f32_32x32x16_bf16 v[64:79], v[128:131], v[160:163], v[64:79]
    ds_read_b128 v[164:167], v19
    ds_read_b64_tr_b16 v[144:145], v20 offset:12288
    ds_read_b64_tr_b16 v[146:147], v20 offset:13312
    s_waitcnt lgkmcnt(7)
    v_mfma_f32_32x32x16_bf16 v[80:95], v[132:135], v[160:163], v[80:95]
    ds_read_b64_tr_b16 v[148:149], v21 offset:12288
    ds_read_b64_tr_b16 v[150:151], v21 offset:13312
    ds_read_b64_tr_b16 v[152:153], v22 offset:12288
    s_waitcnt lgkmcnt(8)
    v_mfma_f32_32x32x16_bf16 v[96:111], v[136:139], v[160:163], v[96:111]
    ds_read_b64_tr_b16 v[154:155], v22 offset:13312
    ds_read_b64_tr_b16 v[156:157], v23 offset:12288
    ds_read_b64_tr_b16 v[158:159], v23 offset:13312
    s_waitcnt lgkmcnt(9)
    v_mfma_f32_32x32x16_bf16 v[112:127], v[140:143], v[160:163], v[112:127]
    s_add_u32 s53, s53, 16384
    s_cmp_eq_u32 s53, 49152
    s_cselect_b32 s53, 0, s53
    v_add_u32 v16, s53, v8
    v_add_u32 v20, s53, v12
    v_add_u32 v17, s53, v9
    v_add_u32 v21, s53, v13
    v_add_u32 v18, s53, v10
    v_add_u32 v22, s53, v14
    v_add_u32 v19, s53, v11
    v_add_u32 v23, s53, v15
    s_waitcnt lgkmcnt(0)
    s_barrier
    s_cmp_eq_u32 s54, 0
    s_cbranch_scc1 P1_LAST
    v_mfma_f32_32x32x16_bf16 v[64:79], v[144:147], v[164:167], v[64:79]
    ds_read_b128 v[160:163], v16
    ds_read_b64_tr_b16 v[128:129], v20 offset:0
    ds_read_b64_tr_b16 v[130:131], v20 offset:1024
    v_mfma_f32_32x32x16_bf16 v[80:95], v[148:151], v[164:167], v[80:95]
    ds_read_b64_tr_b16 v[132:133], v21 offset:0
    ds_read_b64_tr_b16 v[134:135], v21 offset:1024
    ds_read_b64_tr_b16 v[136:137], v22 offset:0
    v_mfma_f32_32x32x16_bf16 v[96:111], v[152:155], v[164:167], v[96:111]
    ds_read_b64_tr_b16 v[138:139], v22 offset:1024
    ds_read_b64_tr_b16 v[140:141], v23 offset:0
    ds_read_b64_tr_b16 v[142:143], v23 offset:1024
    v_mfma_f32_32x32x16_bf16 v[112:127], v[156:159], v[164:167], v[112:127]
    s_sub_u32 s54, s54, 1
    s_branch P1_LOOP
P1_LAST:
    buffer_load_dwordx2 v[6:7], v5, s[28:31], 0 offen sc1
    v_mfma_f32_32x32x16_bf16 v[64:79], v[144:147], v[164:167], v[64:79]
    ds_read_b128 v[192:195], v24
    ds_read_b128 v[224:227], v24 offset:8192
    v_xor_b32 v37, 32, v24
    ds_read_b128 v[196:199], v37
    ds_read_b128 v[228:231], v37 offset:8192
    v_mfma_f32_32x32x16_bf16 v[80:95], v[148:151], v[164:167], v[80:95]
    v_xor_b32 v36, 64, v24
    ds_read_b128 v[200:203], v36
    ds_read_b128 v[232:235], v36 offset:8192
    v_xor_b32 v37, 96, v24
    ds_read_b128 v[204:207], v37
    ds_read_b128 v[236:239], v37 offset:8192
    v_mfma_f32_32x32x16_bf16 v[96:111], v[152:155], v[164:167], v[96:111]
    v_xor_b32 v36, 128, v24
    ds_read_b128 v[208:211], v36
    ds_read_b128 v[240:243], v36 offset:8192
    v_xor_b32 v37, 160, v24
    ds_read_b128 v[212:215], v37
    ds_read_b128 v[244:247], v37 offset:8192
    v_mfma_f32_32x32x16_bf16 v[112:127], v[156:159], v[164:167], v[112:127]
    s_waitcnt lgkmcnt(4)
    v_xor_b32 v36, 192, v24
    ds_read_b128 v[216:219], v36
    ds_read_b128 v[248:251], v36 offset:8192
    v_xor_b32 v37, 224, v24
    ds_read_b128 v[220:223], v37
    ds_read_b128 v[252:255], v37 offset:8192
    s_nop 3
    v_cvt_pk_bf16_f32 v128, v64, v65
    v_cvt_pk_bf16_f32 v129, v66, v67
    v_cvt_pk_bf16_f32 v130, v68, v69
    v_cvt_pk_bf16_f32 v131, v70, v71
    v_cvt_pk_bf16_f32 v132, v72, v73
    v_cvt_pk_bf16_f32 v133, v74, v75
    v_cvt_pk_bf16_f32 v134, v76, v77
    v_cvt_pk_bf16_f32 v135, v78, v79
    v_cvt_pk_bf16_f32 v136, v80, v81
    v_cvt_pk_bf16_f32 v137, v82, v83
    v_cvt_pk_bf16_f32 v138, v84, v85
    v_cvt_pk_bf16_f32 v139, v86, v87
    v_cvt_pk_bf16_f32 v140, v88, v89
    v_cvt_pk_bf16_f32 v141, v90, v91
    v_cvt_pk_bf16_f32 v142, v92, v93
    v_cvt_pk_bf16_f32 v143, v94, v95
    v_cvt_pk_bf16_f32 v144, v96, v97
    v_cvt_pk_bf16_f32 v145, v98, v99
    v_cvt_pk_bf16_f32 v146, v100, v101
    v_cvt_pk_bf16_f32 v147, v102, v103
    v_cvt_pk_bf16_f32 v148, v104, v105
    v_cvt_pk_bf16_f32 v149, v106, v107
    v_cvt_pk_bf16_f32 v150, v108, v109
    v_cvt_pk_bf16_f32 v151, v110, v111
    v_cvt_pk_bf16_f32 v152, v112, v113
    v_cvt_pk_bf16_f32 v153, v114, v115
    v_cvt_pk_bf16_f32 v154, v116, v117
    v_cvt_pk_bf16_f32 v155, v118, v119
    v_cvt_pk_bf16_f32 v156, v120, v121
    v_cvt_pk_bf16_f32 v157, v122, v123
    v_cvt_pk_bf16_f32 v158, v124, v125
    v_cvt_pk_bf16_f32 v159, v126, v127
    s_waitcnt lgkmcnt(0)
    v_mfma_f32_32x32x16_bf16 v[160:175], v[192:195], v[128:131], 0
    v_mfma_f32_32x32x16_bf16 v[176:191], v[224:227], v[128:131], 0
    v_mfma_f32_32x32x16_bf16 v[160:175], v[196:199], v[132:135], v[160:175]
    v_mfma_f32_32x32x16_bf16 v[176:191], v[228:231], v[132:135], v[176:191]
    v_mfma_f32_32x32x16_bf16 v[160:175], v[200:203], v[136:139], v[160:175]
    v_mfma_f32_32x32x16_bf16 v[176:191], v[232:235], v[136:139], v[176:191]
    v_mfma_f32_32x32x16_bf16 v[160:175], v[204:207], v[140:143], v[160:175]
    v_mfma_f32_32x32x16_bf16 v[176:191], v[236:239], v[140:143], v[176:191]
    v_mfma_f32_32x32x16_bf16 v[160:175], v[208:211], v[144:147], v[160:175]
    v_mfma_f32_32x32x16_bf16 v[176:191], v[240:243], v[144:147], v[176:191]
    v_mfma_f32_32x32x16_bf16 v[160:175], v[212:215], v[148:151], v[160:175]
    v_mfma_f32_32x32x16_bf16 v[176:191], v[244:247], v[148:151], v[176:191]
    v_mfma_f32_32x32x16_bf16 v[160:175], v[216:219], v[152:155], v[160:175]
    v_mfma_f32_32x32x16_bf16 v[176:191], v[248:251], v[152:155], v[176:191]
    v_mfma_f32_32x32x16_bf16 v[160:175], v[220:223], v[156:159], v[160:175]
    v_mfma_f32_32x32x16_bf16 v[176:191], v[252:255], v[156:159], v[176:191]
    s_mov_b32 s58, 0x3e0293ee
    s_nop 7
    s_nop 2
    v_max3_f32 v36, v160, v161, v162
    v_max3_f32 v36, v36, v163, v164
    v_max3_f32 v36, v36, v165, v166
    v_max3_f32 v36, v36, v167, v168
    v_max3_f32 v36, v36, v169, v170
    v_max3_f32 v36, v36, v171, v172
    v_max3_f32 v36, v36, v173, v174
    v_max3_f32 v36, v36, v175, v176
    v_max3_f32 v36, v36, v177, v178
    v_max3_f32 v36, v36, v179, v180
    v_max3_f32 v36, v36, v181, v182
    v_max3_f32 v36, v36, v183, v184
    v_max3_f32 v36, v36, v185, v186
    v_max3_f32 v36, v36, v187, v188
    v_max3_f32 v36, v36, v189, v190
    v_max_f32 v36, v36, v191
    v_mov_b32 v37, v36
    s_nop 1
    v_permlane32_swap_b32 v36, v37
    v_max_f32 v36, v36, v37
    v_mul_f32 v36, s58, v36
    v_fma_f32 v160, v160, s58, -v36
    v_fma_f32 v161, v161, s58, -v36
    v_fma_f32 v162, v162, s58, -v36
    v_fma_f32 v163, v163, s58, -v36
    v_fma_f32 v164, v164, s58, -v36
    v_fma_f32 v165, v165, s58, -v36
    v_fma_f32 v166, v166, s58, -v36
    v_fma_f32 v167, v167, s58, -v36
    v_fma_f32 v168, v168, s58, -v36
    v_fma_f32 v169, v169, s58, -v36
    v_fma_f32 v170, v170, s58, -v36
    v_fma_f32 v171, v171, s58, -v36
    v_fma_f32 v172, v172, s58, -v36
    v_fma_f32 v173, v173, s58, -v36
    v_fma_f32 v174, v174, s58, -v36
    v_fma_f32 v175, v175, s58, -v36
    v_fma_f32 v176, v176, s58, -v36
    v_fma_f32 v177, v177, s58, -v36
    v_fma_f32 v178, v178, s58, -v36
    v_fma_f32 v179, v179, s58, -v36
    v_fma_f32 v180, v180, s58, -v36
    v_fma_f32 v181, v181, s58, -v36
    v_fma_f32 v182, v182, s58, -v36
    v_fma_f32 v183, v183, s58, -v36
    v_fma_f32 v184, v184, s58, -v36
    v_fma_f32 v185, v185, s58, -v36
    v_fma_f32 v186, v186, s58, -v36
    v_fma_f32 v187, v187, s58, -v36
    v_fma_f32 v188, v188, s58, -v36
    v_fma_f32 v189, v189, s58, -v36
    v_fma_f32 v190, v190, s58, -v36
    v_fma_f32 v191, v191, s58, -v36
    v_exp_f32 v160, v160
    v_exp_f32 v161, v161
    v_exp_f32 v162, v162
    v_exp_f32 v163, v163
    v_exp_f32 v164, v164
    v_exp_f32 v165, v165
    v_exp_f32 v166, v166
    v_exp_f32 v167, v167
    v_exp_f32 v168, v168
    v_exp_f32 v169, v169
    v_exp_f32 v170, v170
    v_exp_f32 v171, v171
    v_exp_f32 v172, v172
    v_exp_f32 v173, v173
    v_exp_f32 v174, v174
    v_exp_f32 v175, v175
    v_exp_f32 v176, v176
    v_exp_f32 v177, v177
    v_exp_f32 v178, v178
    v_exp_f32 v179, v179
    v_exp_f32 v180, v180
    v_exp_f32 v181, v181
    v_exp_f32 v182, v182
    v_exp_f32 v183, v183
    v_exp_f32 v184, v184
    v_exp_f32 v185, v185
    v_exp_f32 v186, v186
    v_exp_f32 v187, v187
    v_exp_f32 v188, v188
    v_exp_f32 v189, v189
    v_exp_f32 v190, v190
    v_exp_f32 v191, v191
    s_barrier
    ds_read_b64_tr_b16 v[64:65], v26 offset:0
    ds_read_b64_tr_b16 v[66:67], v26 offset:1024
    ds_read_b64_tr_b16 v[68:69], v26 offset:4096
    ds_read_b64_tr_b16 v[70:71], v26 offset:5120
    ds_read_b64_tr_b16 v[72:73], v26 offset:8192
    ds_read_b64_tr_b16 v[74:75], v26 offset:9216
    ds_read_b64_tr_b16 v[76:77], v26 offset:12288
    ds_read_b64_tr_b16 v[78:79], v26 offset:13312
    v_pk_add_f32 v[38:39], v[160:161], v[162:163]
    v_pk_add_f32 v[38:39], v[38:39], v[164:165]
    v_pk_add_f32 v[38:39], v[38:39], v[166:167]
    v_pk_add_f32 v[38:39], v[38:39], v[168:169]
    v_pk_add_f32 v[38:39], v[38:39], v[170:171]
    v_pk_add_f32 v[38:39], v[38:39], v[172:173]
    v_pk_add_f32 v[38:39], v[38:39], v[174:175]
    s_waitcnt lgkmcnt(2)
    ds_read_b64_tr_b16 v[80:81], v27 offset:0
    ds_read_b64_tr_b16 v[82:83], v27 offset:1024
    ds_read_b64_tr_b16 v[84:85], v27 offset:4096
    ds_read_b64_tr_b16 v[86:87], v27 offset:5120
    ds_read_b64_tr_b16 v[88:89], v27 offset:8192
    ds_read_b64_tr_b16 v[90:91], v27 offset:9216
    ds_read_b64_tr_b16 v[92:93], v27 offset:12288
    ds_read_b64_tr_b16 v[94:95], v27 offset:13312
    v_pk_add_f32 v[38:39], v[38:39], v[176:177]
    v_pk_add_f32 v[38:39], v[38:39], v[178:179]
    v_pk_add_f32 v[38:39], v[38:39], v[180:181]
    v_pk_add_f32 v[38:39], v[38:39], v[182:183]
    v_pk_add_f32 v[38:39], v[38:39], v[184:185]
    v_pk_add_f32 v[38:39], v[38:39], v[186:187]
    v_pk_add_f32 v[38:39], v[38:39], v[188:189]
    v_pk_add_f32 v[38:39], v[38:39], v[190:191]
    v_add_f32 v38, v38, v39
    v_mov_b32 v40, v38
    s_waitcnt lgkmcnt(2)
    ds_read_b64_tr_b16 v[96:97], v28 offset:0
    ds_read_b64_tr_b16 v[98:99], v28 offset:1024
    ds_read_b64_tr_b16 v[100:101], v28 offset:4096
    ds_read_b64_tr_b16 v[102:103], v28 offset:5120
    ds_read_b64_tr_b16 v[104:105], v28 offset:8192
    ds_read_b64_tr_b16 v[106:107], v28 offset:9216
    ds_read_b64_tr_b16 v[108:109], v28 offset:12288
    ds_read_b64_tr_b16 v[110:111], v28 offset:13312
    v_permlane32_swap_b32 v38, v40
    v_add_f32 v38, v38, v40
    v_rcp_f32 v38, v38
    s_waitcnt lgkmcnt(2)
    ds_read_b64_tr_b16 v[112:113], v29 offset:0
    ds_read_b64_tr_b16 v[114:115], v29 offset:1024
    ds_read_b64_tr_b16 v[116:117], v29 offset:4096
    ds_read_b64_tr_b16 v[118:119], v29 offset:5120
    ds_read_b64_tr_b16 v[120:121], v29 offset:8192
    ds_read_b64_tr_b16 v[122:123], v29 offset:9216
    ds_read_b64_tr_b16 v[124:125], v29 offset:12288
    ds_read_b64_tr_b16 v[126:127], v29 offset:13312
    v_mov_b32 v39, v38
    v_pk_mul_f32 v[160:161], v[160:161], v[38:39]
    v_pk_mul_f32 v[162:163], v[162:163], v[38:39]
    v_pk_mul_f32 v[164:165], v[164:165], v[38:39]
    v_pk_mul_f32 v[166:167], v[166:167], v[38:39]
    v_pk_mul_f32 v[168:169], v[168:169], v[38:39]
    v_pk_mul_f32 v[170:171], v[170:171], v[38:39]
    v_pk_mul_f32 v[172:173], v[172:173], v[38:39]
    v_pk_mul_f32 v[174:175], v[174:175], v[38:39]
    v_pk_mul_f32 v[176:177], v[176:177], v[38:39]
    v_pk_mul_f32 v[178:179], v[178:179], v[38:39]
    v_pk_mul_f32 v[180:181], v[180:181], v[38:39]
    v_pk_mul_f32 v[182:183], v[182:183], v[38:39]
    v_pk_mul_f32 v[184:185], v[184:185], v[38:39]
    v_pk_mul_f32 v[186:187], v[186:187], v[38:39]
    v_pk_mul_f32 v[188:189], v[188:189], v[38:39]
    v_pk_mul_f32 v[190:191], v[190:191], v[38:39]
    v_cvt_pk_bf16_f32 v128, v160, v161
    v_cvt_pk_bf16_f32 v129, v162, v163
    v_cvt_pk_bf16_f32 v130, v164, v165
    v_cvt_pk_bf16_f32 v131, v166, v167
    v_cvt_pk_bf16_f32 v132, v168, v169
    v_cvt_pk_bf16_f32 v133, v170, v171
    v_cvt_pk_bf16_f32 v134, v172, v173
    v_cvt_pk_bf16_f32 v135, v174, v175
    v_cvt_pk_bf16_f32 v136, v176, v177
    v_cvt_pk_bf16_f32 v137, v178, v179
    v_cvt_pk_bf16_f32 v138, v180, v181
    v_cvt_pk_bf16_f32 v139, v182, v183
    v_cvt_pk_bf16_f32 v140, v184, v185
    v_cvt_pk_bf16_f32 v141, v186, v187
    v_cvt_pk_bf16_f32 v142, v188, v189
    v_cvt_pk_bf16_f32 v143, v190, v191
    s_waitcnt lgkmcnt(0)
    s_nop 0
    v_mfma_f32_32x32x16_bf16 v[192:207], v[64:67], v[128:131], 0
    v_mfma_f32_32x32x16_bf16 v[208:223], v[80:83], v[128:131], 0
    v_mfma_f32_32x32x16_bf16 v[224:239], v[96:99], v[128:131], 0
    v_mfma_f32_32x32x16_bf16 v[240:255], v[112:115], v[128:131], 0
    v_mfma_f32_32x32x16_bf16 v[192:207], v[68:71], v[132:135], v[192:207]
    v_mfma_f32_32x32x16_bf16 v[208:223], v[84:87], v[132:135], v[208:223]
    v_mfma_f32_32x32x16_bf16 v[224:239], v[100:103], v[132:135], v[224:239]
    v_mfma_f32_32x32x16_bf16 v[240:255], v[116:119], v[132:135], v[240:255]
    v_mfma_f32_32x32x16_bf16 v[192:207], v[72:75], v[136:139], v[192:207]
    v_mfma_f32_32x32x16_bf16 v[208:223], v[88:91], v[136:139], v[208:223]
    v_mfma_f32_32x32x16_bf16 v[224:239], v[104:107], v[136:139], v[224:239]
    v_mfma_f32_32x32x16_bf16 v[240:255], v[120:123], v[136:139], v[240:255]
    v_mfma_f32_32x32x16_bf16 v[192:207], v[76:79], v[140:143], v[192:207]
    v_mfma_f32_32x32x16_bf16 v[208:223], v[92:95], v[140:143], v[208:223]
    v_mfma_f32_32x32x16_bf16 v[224:239], v[108:111], v[140:143], v[224:239]
    v_mfma_f32_32x32x16_bf16 v[240:255], v[124:127], v[140:143], v[240:255]
    v_lshrrev_b32 v2, 4, v31
    v_lshlrev_b32 v2, 10, v2
    v_lshl_add_u32 v2, v30, 8, v2
    v_lshl_add_u32 v2, v35, 4, v2
    s_lshl_b32 s55, s46, 2
    s_add_u32 s55, s55, s44
    s_lshl_b32 s55, s55, 18
    s_lshl_b32 s3, s45, 13
    s_add_u32 s50, s55, s3
    s_nop 1
    v_cvt_pk_bf16_f32 v128, v192, v193
    v_cvt_pk_bf16_f32 v129, v194, v195
    v_cvt_pk_bf16_f32 v130, v196, v197
    v_cvt_pk_bf16_f32 v131, v198, v199
    v_cvt_pk_bf16_f32 v132, v200, v201
    v_cvt_pk_bf16_f32 v133, v202, v203
    v_cvt_pk_bf16_f32 v134, v204, v205
    v_cvt_pk_bf16_f32 v135, v206, v207
    s_add_u32 s51, s50, 0
    buffer_store_dwordx4 v[128:131], v2, s[20:23], s51 offen offset:0 sc1
    buffer_store_dwordx4 v[132:135], v2, s[20:23], s51 offen offset:512 sc1
    v_cvt_pk_bf16_f32 v136, v208, v209
    v_cvt_pk_bf16_f32 v137, v210, v211
    v_cvt_pk_bf16_f32 v138, v212, v213
    v_cvt_pk_bf16_f32 v139, v214, v215
    v_cvt_pk_bf16_f32 v140, v216, v217
    v_cvt_pk_bf16_f32 v141, v218, v219
    v_cvt_pk_bf16_f32 v142, v220, v221
    v_cvt_pk_bf16_f32 v143, v222, v223
    s_add_u32 s51, s50, 2048
    buffer_store_dwordx4 v[136:139], v2, s[20:23], s51 offen offset:0 sc1
    buffer_store_dwordx4 v[140:143], v2, s[20:23], s51 offen offset:512 sc1
    v_cvt_pk_bf16_f32 v144, v224, v225
    v_cvt_pk_bf16_f32 v145, v226, v227
    v_cvt_pk_bf16_f32 v146, v228, v229
    v_cvt_pk_bf16_f32 v147, v230, v231
    v_cvt_pk_bf16_f32 v148, v232, v233
    v_cvt_pk_bf16_f32 v149, v234, v235
    v_cvt_pk_bf16_f32 v150, v236, v237
    v_cvt_pk_bf16_f32 v151, v238, v239
    s_add_u32 s51, s50, 4096
    buffer_store_dwordx4 v[144:147], v2, s[20:23], s51 offen offset:0 sc1
    buffer_store_dwordx4 v[148:151], v2, s[20:23], s51 offen offset:512 sc1
    v_cvt_pk_bf16_f32 v152, v240, v241
    v_cvt_pk_bf16_f32 v153, v242, v243
    v_cvt_pk_bf16_f32 v154, v244, v245
    v_cvt_pk_bf16_f32 v155, v246, v247
    v_cvt_pk_bf16_f32 v156, v248, v249
    v_cvt_pk_bf16_f32 v157, v250, v251
    v_cvt_pk_bf16_f32 v158, v252, v253
    v_cvt_pk_bf16_f32 v159, v254, v255
    s_add_u32 s51, s50, 6144
    buffer_store_dwordx4 v[152:155], v2, s[20:23], s51 offen offset:0 sc1
    buffer_store_dwordx4 v[156:159], v2, s[20:23], s51 offen offset:512 sc1
    v_lshrrev_b32 v37, 5, v1
    v_bfe_u32 v36, v1, 4, 1
    v_lshlrev_b32 v2, 4, v37
    v_lshl_add_u32 v2, v36, 2, v2
    v_add_u32 v2, v2, v32
    v_mul_u32_u24 v2, 160, v2
    v_lshl_add_u32 v8, v33, 3, v2
    v_lshlrev_b32 v13, 4, v1
    v_lshlrev_b32 v14, 3, v1
    s_waitcnt vmcnt(0)
    s_mov_b32 s59, 2000000
C_NONCE_POLL:
    v_readfirstlane_b32 s86, v6
    v_readfirstlane_b32 s87, v7
    s_nop 3
    s_cmp_lg_u32 s86, 0
    s_cbranch_scc1 C_NONCE_OK
    s_sub_u32 s59, s59, 1
    s_cbranch_scc1 C_NONCE_OK
    v_mov_b32 v6, 0
    v_mov_b32 v7, 0
    s_mov_b64 exec, 1
    buffer_atomic_or_x2 v[6:7], v5, s[28:31], 0 offen sc0 sc1
    s_mov_b64 exec, -1
    s_waitcnt vmcnt(0)
    s_branch C_NONCE_POLL
C_NONCE_OK:
    s_lshl_b32 s56, s46, 2
    s_add_u32 s56, s56, s48
    s_lshl_b32 s56, s56, 2
    s_add_u32 s56, s56, s44
    s_lshl_b32 s56, s56, 7
    s_add_u32 s56, s56, 18874368
    s_lshl_b32 s3, s47, 3
    v_mov_b32 v6, s86
    v_mov_b32 v7, s87
    v_mov_b32 v2, s3
    s_mov_b64 exec, 1
    buffer_store_dwordx2 v[6:7], v2, s[20:23], s56 offen sc1
    s_mov_b64 exec, -1
    s_barrier
    s_add_u32 s3, s47, 0
    s_and_b32 s3, s3, 7
    s_lshl_b32 s50, s48, 3
    s_add_u32 s3, s3, s50
    s_lshl_b32 s3, s3, 13
    s_add_u32 s57, s55, s3
    buffer_load_dwordx4 v[64:67], v13, s[20:23], s57 offen offset:0 sc1
    buffer_load_dwordx4 v[68:71], v13, s[20:23], s57 offen offset:1024 sc1
    s_add_u32 s50, s57, 2048
    buffer_load_dwordx4 v[72:75], v13, s[20:23], s50 offen offset:0 sc1
    buffer_load_dwordx4 v[76:79], v13, s[20:23], s50 offen offset:1024 sc1
    s_add_u32 s50, s57, 4096
    buffer_load_dwordx4 v[80:83], v13, s[20:23], s50 offen offset:0 sc1
    buffer_load_dwordx4 v[84:87], v13, s[20:23], s50 offen offset:1024 sc1
    s_add_u32 s50, s57, 6144
    buffer_load_dwordx4 v[88:91], v13, s[20:23], s50 offen offset:0 sc1
    buffer_load_dwordx4 v[92:95], v13, s[20:23], s50 offen offset:1024 sc1
    s_mov_b64 exec, 0xff
    s_mov_b32 s59, 2000000
C_POLL1:
    s_cmp_lt_u32 s59, 1999744
    s_cbranch_scc1 C_POLL1_A
    buffer_load_dwordx2 v[38:39], v14, s[20:23], s56 offen sc1
    s_branch C_POLL1_B
C_POLL1_A:
    v_mov_b32 v38, 0
    v_mov_b32 v39, 0
    buffer_atomic_or_x2 v[38:39], v14, s[20:23], s56 offen sc0 sc1
C_POLL1_B:
    s_waitcnt vmcnt(0)
    v_cmp_eq_u64 vcc, s[86:87], v[38:39]
    s_sub_u32 s59, s59, 1
    s_cbranch_scc1 C_POLL1_X
    s_and_b32 s58, vcc_lo, 255
    s_cmp_eq_u32 s58, 255
    s_cbranch_scc0 C_POLL1
C_POLL1_X:
    s_mov_b64 exec, -1
    s_add_u32 s3, s47, 1
    s_and_b32 s3, s3, 7
    s_lshl_b32 s50, s48, 3
    s_add_u32 s3, s3, s50
    s_lshl_b32 s3, s3, 13
    s_add_u32 s57, s55, s3
    buffer_load_dwordx4 v[96:99], v13, s[20:23], s57 offen offset:0 sc1
    buffer_load_dwordx4 v[100:103], v13, s[20:23], s57 offen offset:1024 sc1
    s_add_u32 s50, s57, 2048
    buffer_load_dwordx4 v[104:107], v13, s[20:23], s50 offen offset:0 sc1
    buffer_load_dwordx4 v[108:111], v13, s[20:23], s50 offen offset:1024 sc1
    s_add_u32 s50, s57, 4096
    buffer_load_dwordx4 v[112:115], v13, s[20:23], s50 offen offset:0 sc1
    buffer_load_dwordx4 v[116:119], v13, s[20:23], s50 offen offset:1024 sc1
    s_add_u32 s50, s57, 6144
    buffer_load_dwordx4 v[120:123], v13, s[20:23], s50 offen offset:0 sc1
    buffer_load_dwordx4 v[124:127], v13, s[20:23], s50 offen offset:1024 sc1
    s_barrier
    ds_read_b64_tr_b16 v[176:177], v8 offset:0
    ds_read_b64_tr_b16 v[178:179], v8 offset:1280
    ds_read_b64_tr_b16 v[180:181], v8 offset:32
    ds_read_b64_tr_b16 v[182:183], v8 offset:1312
    ds_read_b64_tr_b16 v[184:185], v8 offset:64
    ds_read_b64_tr_b16 v[186:187], v8 offset:1344
    ds_read_b64_tr_b16 v[188:189], v8 offset:96
    ds_read_b64_tr_b16 v[190:191], v8 offset:1376
    ds_read_b64_tr_b16 v[192:193], v8 offset:128
    ds_read_b64_tr_b16 v[194:195], v8 offset:1408
    s_waitcnt vmcnt(8)
    s_add_u32 s3, s47, 2
    s_and_b32 s3, s3, 7
    s_lshl_b32 s50, s48, 3
    s_add_u32 s3, s3, s50
    s_lshl_b32 s3, s3, 13
    s_add_u32 s57, s55, s3
    s_waitcnt lgkmcnt(8)
    v_mfma_f32_16x16x32_bf16 v[216:219], v[176:179], v[64:67], 0
    ds_read_b64_tr_b16 v[196:197], v8 offset:5120
    ds_read_b64_tr_b16 v[198:199], v8 offset:6400
    v_mfma_f32_16x16x32_bf16 v[220:223], v[176:179], v[68:71], 0
    s_waitcnt lgkmcnt(8)
    v_mfma_f32_16x16x32_bf16 v[224:227], v[180:183], v[64:67], 0
    ds_read_b64_tr_b16 v[200:201], v8 offset:5152
    ds_read_b64_tr_b16 v[202:203], v8 offset:6432
    v_mfma_f32_16x16x32_bf16 v[228:231], v[180:183], v[68:71], 0
    buffer_load_dwordx4 v[128:131], v13, s[20:23], s57 offen offset:0 sc1
    buffer_load_dwordx4 v[132:135], v13, s[20:23], s57 offen offset:1024 sc1
    s_waitcnt lgkmcnt(8)
    v_mfma_f32_16x16x32_bf16 v[232:235], v[184:187], v[64:67], 0
    ds_read_b64_tr_b16 v[204:205], v8 offset:5184
    ds_read_b64_tr_b16 v[206:207], v8 offset:6464
    v_mfma_f32_16x16x32_bf16 v[236:239], v[184:187], v[68:71], 0
    s_waitcnt lgkmcnt(8)
    v_mfma_f32_16x16x32_bf16 v[240:243], v[188:191], v[64:67], 0
    ds_read_b64_tr_b16 v[208:209], v8 offset:5216
    ds_read_b64_tr_b16 v[210:211], v8 offset:6496
    v_mfma_f32_16x16x32_bf16 v[244:247], v[188:191], v[68:71], 0
    s_waitcnt lgkmcnt(8)
    v_mfma_f32_16x16x32_bf16 v[248:251], v[192:195], v[64:67], 0
    ds_read_b64_tr_b16 v[212:213], v8 offset:5248
    ds_read_b64_tr_b16 v[214:215], v8 offset:6528
    v_mfma_f32_16x16x32_bf16 v[252:255], v[192:195], v[68:71], 0
    s_waitcnt lgkmcnt(8)
    v_mfma_f32_16x16x32_bf16 v[216:219], v[196:199], v[72:75], v[216:219]
    ds_read_b64_tr_b16 v[176:177], v8 offset:10240
    ds_read_b64_tr_b16 v[178:179], v8 offset:11520
    v_mfma_f32_16x16x32_bf16 v[220:223], v[196:199], v[76:79], v[220:223]
    s_waitcnt lgkmcnt(8)
    v_mfma_f32_16x16x32_bf16 v[224:227], v[200:203], v[72:75], v[224:227]
    ds_read_b64_tr_b16 v[180:181], v8 offset:10272
    ds_read_b64_tr_b16 v[182:183], v8 offset:11552
    v_mfma_f32_16x16x32_bf16 v[228:231], v[200:203], v[76:79], v[228:231]
    s_add_u32 s50, s57, 2048
    buffer_load_dwordx4 v[136:139], v13, s[20:23], s50 offen offset:0 sc1
    buffer_load_dwordx4 v[140:143], v13, s[20:23], s50 offen offset:1024 sc1
    s_waitcnt lgkmcnt(8)
    v_mfma_f32_16x16x32_bf16 v[232:235], v[204:207], v[72:75], v[232:235]
    ds_read_b64_tr_b16 v[184:185], v8 offset:10304
    ds_read_b64_tr_b16 v[186:187], v8 offset:11584
    v_mfma_f32_16x16x32_bf16 v[236:239], v[204:207], v[76:79], v[236:239]
    s_waitcnt lgkmcnt(8)
    v_mfma_f32_16x16x32_bf16 v[240:243], v[208:211], v[72:75], v[240:243]
    ds_read_b64_tr_b16 v[188:189], v8 offset:10336
    ds_read_b64_tr_b16 v[190:191], v8 offset:11616
    v_mfma_f32_16x16x32_bf16 v[244:247], v[208:211], v[76:79], v[244:247]
    s_waitcnt lgkmcnt(8)
    v_mfma_f32_16x16x32_bf16 v[248:251], v[212:215], v[72:75], v[248:251]
    ds_read_b64_tr_b16 v[192:193], v8 offset:10368
    ds_read_b64_tr_b16 v[194:195], v8 offset:11648
    v_mfma_f32_16x16x32_bf16 v[252:255], v[212:215], v[76:79], v[252:255]
    s_waitcnt lgkmcnt(8)
    v_mfma_f32_16x16x32_bf16 v[216:219], v[176:179], v[80:83], v[216:219]
    ds_read_b64_tr_b16 v[196:197], v8 offset:15360
    ds_read_b64_tr_b16 v[198:199], v8 offset:16640
    v_mfma_f32_16x16x32_bf16 v[220:223], v[176:179], v[84:87], v[220:223]
    s_waitcnt lgkmcnt(8)
    v_mfma_f32_16x16x32_bf16 v[224:227], v[180:183], v[80:83], v[224:227]
    ds_read_b64_tr_b16 v[200:201], v8 offset:15392
    ds_read_b64_tr_b16 v[202:203], v8 offset:16672
    v_mfma_f32_16x16x32_bf16 v[228:231], v[180:183], v[84:87], v[228:231]
    s_add_u32 s50, s57, 4096
    buffer_load_dwordx4 v[144:147], v13, s[20:23], s50 offen offset:0 sc1
    buffer_load_dwordx4 v[148:151], v13, s[20:23], s50 offen offset:1024 sc1
    s_waitcnt lgkmcnt(8)
    v_mfma_f32_16x16x32_bf16 v[232:235], v[184:187], v[80:83], v[232:235]
    ds_read_b64_tr_b16 v[204:205], v8 offset:15424
    ds_read_b64_tr_b16 v[206:207], v8 offset:16704
    v_mfma_f32_16x16x32_bf16 v[236:239], v[184:187], v[84:87], v[236:239]
    s_waitcnt lgkmcnt(8)
    v_mfma_f32_16x16x32_bf16 v[240:243], v[188:191], v[80:83], v[240:243]
    ds_read_b64_tr_b16 v[208:209], v8 offset:15456
    ds_read_b64_tr_b16 v[210:211], v8 offset:16736
    v_mfma_f32_16x16x32_bf16 v[244:247], v[188:191], v[84:87], v[244:247]
    s_waitcnt lgkmcnt(8)
    v_mfma_f32_16x16x32_bf16 v[248:251], v[192:195], v[80:83], v[248:251]
    ds_read_b64_tr_b16 v[212:213], v8 offset:15488
    ds_read_b64_tr_b16 v[214:215], v8 offset:16768
    v_mfma_f32_16x16x32_bf16 v[252:255], v[192:195], v[84:87], v[252:255]
    s_waitcnt lgkmcnt(8)
    v_mfma_f32_16x16x32_bf16 v[216:219], v[196:199], v[88:91], v[216:219]
    ds_read_b64_tr_b16 v[176:177], v8 offset:20480
    ds_read_b64_tr_b16 v[178:179], v8 offset:21760
    v_mfma_f32_16x16x32_bf16 v[220:223], v[196:199], v[92:95], v[220:223]
    s_waitcnt lgkmcnt(8)
    v_mfma_f32_16x16x32_bf16 v[224:227], v[200:203], v[88:91], v[224:227]
    ds_read_b64_tr_b16 v[180:181], v8 offset:20512
    ds_read_b64_tr_b16 v[182:183], v8 offset:21792
    v_mfma_f32_16x16x32_bf16 v[228:231], v[200:203], v[92:95], v[228:231]
    s_add_u32 s50, s57, 6144
    buffer_load_dwordx4 v[152:155], v13, s[20:23], s50 offen offset:0 sc1
    buffer_load_dwordx4 v[156:159], v13, s[20:23], s50 offen offset:1024 sc1
    s_waitcnt lgkmcnt(8)
    v_mfma_f32_16x16x32_bf16 v[232:235], v[204:207], v[88:91], v[232:235]
    ds_read_b64_tr_b16 v[184:185], v8 offset:20544
    ds_read_b64_tr_b16 v[186:187], v8 offset:21824
    v_mfma_f32_16x16x32_bf16 v[236:239], v[204:207], v[92:95], v[236:239]
    s_waitcnt lgkmcnt(8)
    v_mfma_f32_16x16x32_bf16 v[240:243], v[208:211], v[88:91], v[240:243]
    ds_read_b64_tr_b16 v[188:189], v8 offset:20576
    ds_read_b64_tr_b16 v[190:191], v8 offset:21856
    v_mfma_f32_16x16x32_bf16 v[244:247], v[208:211], v[92:95], v[244:247]
    s_waitcnt lgkmcnt(8)
    v_mfma_f32_16x16x32_bf16 v[248:251], v[212:215], v[88:91], v[248:251]
    ds_read_b64_tr_b16 v[192:193], v8 offset:20608
    ds_read_b64_tr_b16 v[194:195], v8 offset:21888
    v_mfma_f32_16x16x32_bf16 v[252:255], v[212:215], v[92:95], v[252:255]
    s_waitcnt vmcnt(8)
    s_add_u32 s3, s47, 3
    s_and_b32 s3, s3, 7
    s_lshl_b32 s50, s48, 3
    s_add_u32 s3, s3, s50
    s_lshl_b32 s3, s3, 13
    s_add_u32 s57, s55, s3
    s_waitcnt lgkmcnt(8)
    v_mfma_f32_16x16x32_bf16 v[216:219], v[176:179], v[96:99], v[216:219]
    ds_read_b64_tr_b16 v[196:197], v8 offset:25600
    ds_read_b64_tr_b16 v[198:199], v8 offset:26880
    v_mfma_f32_16x16x32_bf16 v[220:223], v[176:179], v[100:103], v[220:223]
    s_waitcnt lgkmcnt(8)
    v_mfma_f32_16x16x32_bf16 v[224:227], v[180:183], v[96:99], v[224:227]
    ds_read_b64_tr_b16 v[200:201], v8 offset:25632
    ds_read_b64_tr_b16 v[202:203], v8 offset:26912
    v_mfma_f32_16x16x32_bf16 v[228:231], v[180:183], v[100:103], v[228:231]
    buffer_load_dwordx4 v[64:67], v13, s[20:23], s57 offen offset:0 sc1
    buffer_load_dwordx4 v[68:71], v13, s[20:23], s57 offen offset:1024 sc1
    s_waitcnt lgkmcnt(8)
    v_mfma_f32_16x16x32_bf16 v[232:235], v[184:187], v[96:99], v[232:235]
    ds_read_b64_tr_b16 v[204:205], v8 offset:25664
    ds_read_b64_tr_b16 v[206:207], v8 offset:26944
    v_mfma_f32_16x16x32_bf16 v[236:239], v[184:187], v[100:103], v[236:239]
    s_waitcnt lgkmcnt(8)
    v_mfma_f32_16x16x32_bf16 v[240:243], v[188:191], v[96:99], v[240:243]
    ds_read_b64_tr_b16 v[208:209], v8 offset:25696
    ds_read_b64_tr_b16 v[210:211], v8 offset:26976
    v_mfma_f32_16x16x32_bf16 v[244:247], v[188:191], v[100:103], v[244:247]
    s_waitcnt lgkmcnt(8)
    v_mfma_f32_16x16x32_bf16 v[248:251], v[192:195], v[96:99], v[248:251]
    ds_read_b64_tr_b16 v[212:213], v8 offset:25728
    ds_read_b64_tr_b16 v[214:215], v8 offset:27008
    v_mfma_f32_16x16x32_bf16 v[252:255], v[192:195], v[100:103], v[252:255]
    s_waitcnt lgkmcnt(8)
    v_mfma_f32_16x16x32_bf16 v[216:219], v[196:199], v[104:107], v[216:219]
    ds_read_b64_tr_b16 v[176:177], v8 offset:30720
    ds_read_b64_tr_b16 v[178:179], v8 offset:32000
    v_mfma_f32_16x16x32_bf16 v[220:223], v[196:199], v[108:111], v[220:223]
    s_waitcnt lgkmcnt(8)
    v_mfma_f32_16x16x32_bf16 v[224:227], v[200:203], v[104:107], v[224:227]
    ds_read_b64_tr_b16 v[180:181], v8 offset:30752
    ds_read_b64_tr_b16 v[182:183], v8 offset:32032
    v_mfma_f32_16x16x32_bf16 v[228:231], v[200:203], v[108:111], v[228:231]
    s_add_u32 s50, s57, 2048
    buffer_load_dwordx4 v[72:75], v13, s[20:23], s50 offen offset:0 sc1
    buffer_load_dwordx4 v[76:79], v13, s[20:23], s50 offen offset:1024 sc1
    s_waitcnt lgkmcnt(8)
    v_mfma_f32_16x16x32_bf16 v[232:235], v[204:207], v[104:107], v[232:235]
    ds_read_b64_tr_b16 v[184:185], v8 offset:30784
    ds_read_b64_tr_b16 v[186:187], v8 offset:32064
    v_mfma_f32_16x16x32_bf16 v[236:239], v[204:207], v[108:111], v[236:239]
    s_waitcnt lgkmcnt(8)
    v_mfma_f32_16x16x32_bf16 v[240:243], v[208:211], v[104:107], v[240:243]
    ds_read_b64_tr_b16 v[188:189], v8 offset:30816
    ds_read_b64_tr_b16 v[190:191], v8 offset:32096
    v_mfma_f32_16x16x32_bf16 v[244:247], v[208:211], v[108:111], v[244:247]
    s_waitcnt lgkmcnt(8)
    v_mfma_f32_16x16x32_bf16 v[248:251], v[212:215], v[104:107], v[248:251]
    ds_read_b64_tr_b16 v[192:193], v8 offset:30848
    ds_read_b64_tr_b16 v[194:195], v8 offset:32128
    v_mfma_f32_16x16x32_bf16 v[252:255], v[212:215], v[108:111], v[252:255]
    s_waitcnt lgkmcnt(8)
    v_mfma_f32_16x16x32_bf16 v[216:219], v[176:179], v[112:115], v[216:219]
    ds_read_b64_tr_b16 v[196:197], v8 offset:35840
    ds_read_b64_tr_b16 v[198:199], v8 offset:37120
    v_mfma_f32_16x16x32_bf16 v[220:223], v[176:179], v[116:119], v[220:223]
    s_waitcnt lgkmcnt(8)
    v_mfma_f32_16x16x32_bf16 v[224:227], v[180:183], v[112:115], v[224:227]
    ds_read_b64_tr_b16 v[200:201], v8 offset:35872
    ds_read_b64_tr_b16 v[202:203], v8 offset:37152
    v_mfma_f32_16x16x32_bf16 v[228:231], v[180:183], v[116:119], v[228:231]
    s_add_u32 s50, s57, 4096
    buffer_load_dwordx4 v[80:83], v13, s[20:23], s50 offen offset:0 sc1
    buffer_load_dwordx4 v[84:87], v13, s[20:23], s50 offen offset:1024 sc1
    s_waitcnt lgkmcnt(8)
    v_mfma_f32_16x16x32_bf16 v[232:235], v[184:187], v[112:115], v[232:235]
    ds_read_b64_tr_b16 v[204:205], v8 offset:35904
    ds_read_b64_tr_b16 v[206:207], v8 offset:37184
    v_mfma_f32_16x16x32_bf16 v[236:239], v[184:187], v[116:119], v[236:239]
    s_waitcnt lgkmcnt(8)
    v_mfma_f32_16x16x32_bf16 v[240:243], v[188:191], v[112:115], v[240:243]
    ds_read_b64_tr_b16 v[208:209], v8 offset:35936
    ds_read_b64_tr_b16 v[210:211], v8 offset:37216
    v_mfma_f32_16x16x32_bf16 v[244:247], v[188:191], v[116:119], v[244:247]
    s_waitcnt lgkmcnt(8)
    v_mfma_f32_16x16x32_bf16 v[248:251], v[192:195], v[112:115], v[248:251]
    ds_read_b64_tr_b16 v[212:213], v8 offset:35968
    ds_read_b64_tr_b16 v[214:215], v8 offset:37248
    v_mfma_f32_16x16x32_bf16 v[252:255], v[192:195], v[116:119], v[252:255]
    v_add_u32 v8, 40960, v8
    s_waitcnt lgkmcnt(8)
    v_mfma_f32_16x16x32_bf16 v[216:219], v[196:199], v[120:123], v[216:219]
    ds_read_b64_tr_b16 v[176:177], v8 offset:0
    ds_read_b64_tr_b16 v[178:179], v8 offset:1280
    v_mfma_f32_16x16x32_bf16 v[220:223], v[196:199], v[124:127], v[220:223]
    s_waitcnt lgkmcnt(8)
    v_mfma_f32_16x16x32_bf16 v[224:227], v[200:203], v[120:123], v[224:227]
    ds_read_b64_tr_b16 v[180:181], v8 offset:32
    ds_read_b64_tr_b16 v[182:183], v8 offset:1312
    v_mfma_f32_16x16x32_bf16 v[228:231], v[200:203], v[124:127], v[228:231]
    s_add_u32 s50, s57, 6144
    buffer_load_dwordx4 v[88:91], v13, s[20:23], s50 offen offset:0 sc1
    buffer_load_dwordx4 v[92:95], v13, s[20:23], s50 offen offset:1024 sc1
    s_waitcnt lgkmcnt(8)
    v_mfma_f32_16x16x32_bf16 v[232:235], v[204:207], v[120:123], v[232:235]
    ds_read_b64_tr_b16 v[184:185], v8 offset:64
    ds_read_b64_tr_b16 v[186:187], v8 offset:1344
    v_mfma_f32_16x16x32_bf16 v[236:239], v[204:207], v[124:127], v[236:239]
    s_waitcnt lgkmcnt(8)
    v_mfma_f32_16x16x32_bf16 v[240:243], v[208:211], v[120:123], v[240:243]
    ds_read_b64_tr_b16 v[188:189], v8 offset:96
    ds_read_b64_tr_b16 v[190:191], v8 offset:1376
    v_mfma_f32_16x16x32_bf16 v[244:247], v[208:211], v[124:127], v[244:247]
    s_waitcnt lgkmcnt(8)
    v_mfma_f32_16x16x32_bf16 v[248:251], v[212:215], v[120:123], v[248:251]
    ds_read_b64_tr_b16 v[192:193], v8 offset:128
    ds_read_b64_tr_b16 v[194:195], v8 offset:1408
    v_mfma_f32_16x16x32_bf16 v[252:255], v[212:215], v[124:127], v[252:255]
    s_waitcnt vmcnt(8)
    s_add_u32 s3, s47, 4
    s_and_b32 s3, s3, 7
    s_lshl_b32 s50, s48, 3
    s_add_u32 s3, s3, s50
    s_lshl_b32 s3, s3, 13
    s_add_u32 s57, s55, s3
    s_waitcnt lgkmcnt(8)
    v_mfma_f32_16x16x32_bf16 v[216:219], v[176:179], v[128:131], v[216:219]
    ds_read_b64_tr_b16 v[196:197], v8 offset:5120
    ds_read_b64_tr_b16 v[198:199], v8 offset:6400
    v_mfma_f32_16x16x32_bf16 v[220:223], v[176:179], v[132:135], v[220:223]
    s_waitcnt lgkmcnt(8)
    v_mfma_f32_16x16x32_bf16 v[224:227], v[180:183], v[128:131], v[224:227]
    ds_read_b64_tr_b16 v[200:201], v8 offset:5152
    ds_read_b64_tr_b16 v[202:203], v8 offset:6432
    v_mfma_f32_16x16x32_bf16 v[228:231], v[180:183], v[132:135], v[228:231]
    buffer_load_dwordx4 v[96:99], v13, s[20:23], s57 offen offset:0 sc1
    buffer_load_dwordx4 v[100:103], v13, s[20:23], s57 offen offset:1024 sc1
    s_waitcnt lgkmcnt(8)
    v_mfma_f32_16x16x32_bf16 v[232:235], v[184:187], v[128:131], v[232:235]
    ds_read_b64_tr_b16 v[204:205], v8 offset:5184
    ds_read_b64_tr_b16 v[206:207], v8 offset:6464
    v_mfma_f32_16x16x32_bf16 v[236:239], v[184:187], v[132:135], v[236:239]
    s_waitcnt lgkmcnt(8)
    v_mfma_f32_16x16x32_bf16 v[240:243], v[188:191], v[128:131], v[240:243]
    ds_read_b64_tr_b16 v[208:209], v8 offset:5216
    ds_read_b64_tr_b16 v[210:211], v8 offset:6496
    v_mfma_f32_16x16x32_bf16 v[244:247], v[188:191], v[132:135], v[244:247]
    s_waitcnt lgkmcnt(8)
    v_mfma_f32_16x16x32_bf16 v[248:251], v[192:195], v[128:131], v[248:251]
    ds_read_b64_tr_b16 v[212:213], v8 offset:5248
    ds_read_b64_tr_b16 v[214:215], v8 offset:6528
    v_mfma_f32_16x16x32_bf16 v[252:255], v[192:195], v[132:135], v[252:255]
    s_waitcnt lgkmcnt(8)
    v_mfma_f32_16x16x32_bf16 v[216:219], v[196:199], v[136:139], v[216:219]
    ds_read_b64_tr_b16 v[176:177], v8 offset:10240
    ds_read_b64_tr_b16 v[178:179], v8 offset:11520
    v_mfma_f32_16x16x32_bf16 v[220:223], v[196:199], v[140:143], v[220:223]
    s_waitcnt lgkmcnt(8)
    v_mfma_f32_16x16x32_bf16 v[224:227], v[200:203], v[136:139], v[224:227]
    ds_read_b64_tr_b16 v[180:181], v8 offset:10272
    ds_read_b64_tr_b16 v[182:183], v8 offset:11552
    v_mfma_f32_16x16x32_bf16 v[228:231], v[200:203], v[140:143], v[228:231]
    s_add_u32 s50, s57, 2048
    buffer_load_dwordx4 v[104:107], v13, s[20:23], s50 offen offset:0 sc1
    buffer_load_dwordx4 v[108:111], v13, s[20:23], s50 offen offset:1024 sc1
    s_waitcnt lgkmcnt(8)
    v_mfma_f32_16x16x32_bf16 v[232:235], v[204:207], v[136:139], v[232:235]
    ds_read_b64_tr_b16 v[184:185], v8 offset:10304
    ds_read_b64_tr_b16 v[186:187], v8 offset:11584
    v_mfma_f32_16x16x32_bf16 v[236:239], v[204:207], v[140:143], v[236:239]
    s_waitcnt lgkmcnt(8)
    v_mfma_f32_16x16x32_bf16 v[240:243], v[208:211], v[136:139], v[240:243]
    ds_read_b64_tr_b16 v[188:189], v8 offset:10336
    ds_read_b64_tr_b16 v[190:191], v8 offset:11616
    v_mfma_f32_16x16x32_bf16 v[244:247], v[208:211], v[140:143], v[244:247]
    s_waitcnt lgkmcnt(8)
    v_mfma_f32_16x16x32_bf16 v[248:251], v[212:215], v[136:139], v[248:251]
    ds_read_b64_tr_b16 v[192:193], v8 offset:10368
    ds_read_b64_tr_b16 v[194:195], v8 offset:11648
    v_mfma_f32_16x16x32_bf16 v[252:255], v[212:215], v[140:143], v[252:255]
    s_waitcnt lgkmcnt(8)
    v_mfma_f32_16x16x32_bf16 v[216:219], v[176:179], v[144:147], v[216:219]
    ds_read_b64_tr_b16 v[196:197], v8 offset:15360
    ds_read_b64_tr_b16 v[198:199], v8 offset:16640
    v_mfma_f32_16x16x32_bf16 v[220:223], v[176:179], v[148:151], v[220:223]
    s_waitcnt lgkmcnt(8)
    v_mfma_f32_16x16x32_bf16 v[224:227], v[180:183], v[144:147], v[224:227]
    ds_read_b64_tr_b16 v[200:201], v8 offset:15392
    ds_read_b64_tr_b16 v[202:203], v8 offset:16672
    v_mfma_f32_16x16x32_bf16 v[228:231], v[180:183], v[148:151], v[228:231]
    s_add_u32 s50, s57, 4096
    buffer_load_dwordx4 v[112:115], v13, s[20:23], s50 offen offset:0 sc1
    buffer_load_dwordx4 v[116:119], v13, s[20:23], s50 offen offset:1024 sc1
    s_waitcnt lgkmcnt(8)
    v_mfma_f32_16x16x32_bf16 v[232:235], v[184:187], v[144:147], v[232:235]
    ds_read_b64_tr_b16 v[204:205], v8 offset:15424
    ds_read_b64_tr_b16 v[206:207], v8 offset:16704
    v_mfma_f32_16x16x32_bf16 v[236:239], v[184:187], v[148:151], v[236:239]
    s_waitcnt lgkmcnt(8)
    v_mfma_f32_16x16x32_bf16 v[240:243], v[188:191], v[144:147], v[240:243]
    ds_read_b64_tr_b16 v[208:209], v8 offset:15456
    ds_read_b64_tr_b16 v[210:211], v8 offset:16736
    v_mfma_f32_16x16x32_bf16 v[244:247], v[188:191], v[148:151], v[244:247]
    s_waitcnt lgkmcnt(8)
    v_mfma_f32_16x16x32_bf16 v[248:251], v[192:195], v[144:147], v[248:251]
    ds_read_b64_tr_b16 v[212:213], v8 offset:15488
    ds_read_b64_tr_b16 v[214:215], v8 offset:16768
    v_mfma_f32_16x16x32_bf16 v[252:255], v[192:195], v[148:151], v[252:255]
    s_waitcnt lgkmcnt(8)
    v_mfma_f32_16x16x32_bf16 v[216:219], v[196:199], v[152:155], v[216:219]
    ds_read_b64_tr_b16 v[176:177], v8 offset:20480
    ds_read_b64_tr_b16 v[178:179], v8 offset:21760
    v_mfma_f32_16x16x32_bf16 v[220:223], v[196:199], v[156:159], v[220:223]
    s_waitcnt lgkmcnt(8)
    v_mfma_f32_16x16x32_bf16 v[224:227], v[200:203], v[152:155], v[224:227]
    ds_read_b64_tr_b16 v[180:181], v8 offset:20512
    ds_read_b64_tr_b16 v[182:183], v8 offset:21792
    v_mfma_f32_16x16x32_bf16 v[228:231], v[200:203], v[156:159], v[228:231]
    s_add_u32 s50, s57, 6144
    buffer_load_dwordx4 v[120:123], v13, s[20:23], s50 offen offset:0 sc1
    buffer_load_dwordx4 v[124:127], v13, s[20:23], s50 offen offset:1024 sc1
    s_waitcnt lgkmcnt(8)
    v_mfma_f32_16x16x32_bf16 v[232:235], v[204:207], v[152:155], v[232:235]
    ds_read_b64_tr_b16 v[184:185], v8 offset:20544
    ds_read_b64_tr_b16 v[186:187], v8 offset:21824
    v_mfma_f32_16x16x32_bf16 v[236:239], v[204:207], v[156:159], v[236:239]
    s_waitcnt lgkmcnt(8)
    v_mfma_f32_16x16x32_bf16 v[240:243], v[208:211], v[152:155], v[240:243]
    ds_read_b64_tr_b16 v[188:189], v8 offset:20576
    ds_read_b64_tr_b16 v[190:191], v8 offset:21856
    v_mfma_f32_16x16x32_bf16 v[244:247], v[208:211], v[156:159], v[244:247]
    s_waitcnt lgkmcnt(8)
    v_mfma_f32_16x16x32_bf16 v[248:251], v[212:215], v[152:155], v[248:251]
    ds_read_b64_tr_b16 v[192:193], v8 offset:20608
    ds_read_b64_tr_b16 v[194:195], v8 offset:21888
    v_mfma_f32_16x16x32_bf16 v[252:255], v[212:215], v[156:159], v[252:255]
    s_waitcnt vmcnt(8)
    s_add_u32 s3, s47, 5
    s_and_b32 s3, s3, 7
    s_lshl_b32 s50, s48, 3
    s_add_u32 s3, s3, s50
    s_lshl_b32 s3, s3, 13
    s_add_u32 s57, s55, s3
    s_waitcnt lgkmcnt(8)
    v_mfma_f32_16x16x32_bf16 v[216:219], v[176:179], v[64:67], v[216:219]
    ds_read_b64_tr_b16 v[196:197], v8 offset:25600
    ds_read_b64_tr_b16 v[198:199], v8 offset:26880
    v_mfma_f32_16x16x32_bf16 v[220:223], v[176:179], v[68:71], v[220:223]
    s_waitcnt lgkmcnt(8)
    v_mfma_f32_16x16x32_bf16 v[224:227], v[180:183], v[64:67], v[224:227]
    ds_read_b64_tr_b16 v[200:201], v8 offset:25632
    ds_read_b64_tr_b16 v[202:203], v8 offset:26912
    v_mfma_f32_16x16x32_bf16 v[228:231], v[180:183], v[68:71], v[228:231]
    buffer_load_dwordx4 v[128:131], v13, s[20:23], s57 offen offset:0 sc1
    buffer_load_dwordx4 v[132:135], v13, s[20:23], s57 offen offset:1024 sc1
    s_waitcnt lgkmcnt(8)
    v_mfma_f32_16x16x32_bf16 v[232:235], v[184:187], v[64:67], v[232:235]
    ds_read_b64_tr_b16 v[204:205], v8 offset:25664
    ds_read_b64_tr_b16 v[206:207], v8 offset:26944
    v_mfma_f32_16x16x32_bf16 v[236:239], v[184:187], v[68:71], v[236:239]
    s_waitcnt lgkmcnt(8)
    v_mfma_f32_16x16x32_bf16 v[240:243], v[188:191], v[64:67], v[240:243]
    ds_read_b64_tr_b16 v[208:209], v8 offset:25696
    ds_read_b64_tr_b16 v[210:211], v8 offset:26976
    v_mfma_f32_16x16x32_bf16 v[244:247], v[188:191], v[68:71], v[244:247]
    s_waitcnt lgkmcnt(8)
    v_mfma_f32_16x16x32_bf16 v[248:251], v[192:195], v[64:67], v[248:251]
    ds_read_b64_tr_b16 v[212:213], v8 offset:25728
    ds_read_b64_tr_b16 v[214:215], v8 offset:27008
    v_mfma_f32_16x16x32_bf16 v[252:255], v[192:195], v[68:71], v[252:255]
    s_waitcnt lgkmcnt(8)
    v_mfma_f32_16x16x32_bf16 v[216:219], v[196:199], v[72:75], v[216:219]
    ds_read_b64_tr_b16 v[176:177], v8 offset:30720
    ds_read_b64_tr_b16 v[178:179], v8 offset:32000
    v_mfma_f32_16x16x32_bf16 v[220:223], v[196:199], v[76:79], v[220:223]
    s_waitcnt lgkmcnt(8)
    v_mfma_f32_16x16x32_bf16 v[224:227], v[200:203], v[72:75], v[224:227]
    ds_read_b64_tr_b16 v[180:181], v8 offset:30752
    ds_read_b64_tr_b16 v[182:183], v8 offset:32032
    v_mfma_f32_16x16x32_bf16 v[228:231], v[200:203], v[76:79], v[228:231]
    s_add_u32 s50, s57, 2048
    buffer_load_dwordx4 v[136:139], v13, s[20:23], s50 offen offset:0 sc1
    buffer_load_dwordx4 v[140:143], v13, s[20:23], s50 offen offset:1024 sc1
    s_waitcnt lgkmcnt(8)
    v_mfma_f32_16x16x32_bf16 v[232:235], v[204:207], v[72:75], v[232:235]
    ds_read_b64_tr_b16 v[184:185], v8 offset:30784
    ds_read_b64_tr_b16 v[186:187], v8 offset:32064
    v_mfma_f32_16x16x32_bf16 v[236:239], v[204:207], v[76:79], v[236:239]
    s_waitcnt lgkmcnt(8)
    v_mfma_f32_16x16x32_bf16 v[240:243], v[208:211], v[72:75], v[240:243]
    ds_read_b64_tr_b16 v[188:189], v8 offset:30816
    ds_read_b64_tr_b16 v[190:191], v8 offset:32096
    v_mfma_f32_16x16x32_bf16 v[244:247], v[208:211], v[76:79], v[244:247]
    s_waitcnt lgkmcnt(8)
    v_mfma_f32_16x16x32_bf16 v[248:251], v[212:215], v[72:75], v[248:251]
    ds_read_b64_tr_b16 v[192:193], v8 offset:30848
    ds_read_b64_tr_b16 v[194:195], v8 offset:32128
    v_mfma_f32_16x16x32_bf16 v[252:255], v[212:215], v[76:79], v[252:255]
    s_waitcnt lgkmcnt(8)
    v_mfma_f32_16x16x32_bf16 v[216:219], v[176:179], v[80:83], v[216:219]
    ds_read_b64_tr_b16 v[196:197], v8 offset:35840
    ds_read_b64_tr_b16 v[198:199], v8 offset:37120
    v_mfma_f32_16x16x32_bf16 v[220:223], v[176:179], v[84:87], v[220:223]
    s_waitcnt lgkmcnt(8)
    v_mfma_f32_16x16x32_bf16 v[224:227], v[180:183], v[80:83], v[224:227]
    ds_read_b64_tr_b16 v[200:201], v8 offset:35872
    ds_read_b64_tr_b16 v[202:203], v8 offset:37152
    v_mfma_f32_16x16x32_bf16 v[228:231], v[180:183], v[84:87], v[228:231]
    s_add_u32 s50, s57, 4096
    buffer_load_dwordx4 v[144:147], v13, s[20:23], s50 offen offset:0 sc1
    buffer_load_dwordx4 v[148:151], v13, s[20:23], s50 offen offset:1024 sc1
    s_waitcnt lgkmcnt(8)
    v_mfma_f32_16x16x32_bf16 v[232:235], v[184:187], v[80:83], v[232:235]
    ds_read_b64_tr_b16 v[204:205], v8 offset:35904
    ds_read_b64_tr_b16 v[206:207], v8 offset:37184
    v_mfma_f32_16x16x32_bf16 v[236:239], v[184:187], v[84:87], v[236:239]
    s_waitcnt lgkmcnt(8)
    v_mfma_f32_16x16x32_bf16 v[240:243], v[188:191], v[80:83], v[240:243]
    ds_read_b64_tr_b16 v[208:209], v8 offset:35936
    ds_read_b64_tr_b16 v[210:211], v8 offset:37216
    v_mfma_f32_16x16x32_bf16 v[244:247], v[188:191], v[84:87], v[244:247]
    s_waitcnt lgkmcnt(8)
    v_mfma_f32_16x16x32_bf16 v[248:251], v[192:195], v[80:83], v[248:251]
    ds_read_b64_tr_b16 v[212:213], v8 offset:35968
    ds_read_b64_tr_b16 v[214:215], v8 offset:37248
    v_mfma_f32_16x16x32_bf16 v[252:255], v[192:195], v[84:87], v[252:255]
    v_add_u32 v8, 40960, v8
    s_waitcnt lgkmcnt(8)
    v_mfma_f32_16x16x32_bf16 v[216:219], v[196:199], v[88:91], v[216:219]
    ds_read_b64_tr_b16 v[176:177], v8 offset:0
    ds_read_b64_tr_b16 v[178:179], v8 offset:1280
    v_mfma_f32_16x16x32_bf16 v[220:223], v[196:199], v[92:95], v[220:223]
    s_waitcnt lgkmcnt(8)
    v_mfma_f32_16x16x32_bf16 v[224:227], v[200:203], v[88:91], v[224:227]
    ds_read_b64_tr_b16 v[180:181], v8 offset:32
    ds_read_b64_tr_b16 v[182:183], v8 offset:1312
    v_mfma_f32_16x16x32_bf16 v[228:231], v[200:203], v[92:95], v[228:231]
    s_add_u32 s50, s57, 6144
    buffer_load_dwordx4 v[152:155], v13, s[20:23], s50 offen offset:0 sc1
    buffer_load_dwordx4 v[156:159], v13, s[20:23], s50 offen offset:1024 sc1
    s_waitcnt lgkmcnt(8)
    v_mfma_f32_16x16x32_bf16 v[232:235], v[204:207], v[88:91], v[232:235]
    ds_read_b64_tr_b16 v[184:185], v8 offset:64
    ds_read_b64_tr_b16 v[186:187], v8 offset:1344
    v_mfma_f32_16x16x32_bf16 v[236:239], v[204:207], v[92:95], v[236:239]
    s_waitcnt lgkmcnt(8)
    v_mfma_f32_16x16x32_bf16 v[240:243], v[208:211], v[88:91], v[240:243]
    ds_read_b64_tr_b16 v[188:189], v8 offset:96
    ds_read_b64_tr_b16 v[190:191], v8 offset:1376
    v_mfma_f32_16x16x32_bf16 v[244:247], v[208:211], v[92:95], v[244:247]
    s_waitcnt lgkmcnt(8)
    v_mfma_f32_16x16x32_bf16 v[248:251], v[212:215], v[88:91], v[248:251]
    ds_read_b64_tr_b16 v[192:193], v8 offset:128
    ds_read_b64_tr_b16 v[194:195], v8 offset:1408
    v_mfma_f32_16x16x32_bf16 v[252:255], v[212:215], v[92:95], v[252:255]
    s_waitcnt vmcnt(8)
    s_add_u32 s3, s47, 6
    s_and_b32 s3, s3, 7
    s_lshl_b32 s50, s48, 3
    s_add_u32 s3, s3, s50
    s_lshl_b32 s3, s3, 13
    s_add_u32 s57, s55, s3
    s_waitcnt lgkmcnt(8)
    v_mfma_f32_16x16x32_bf16 v[216:219], v[176:179], v[96:99], v[216:219]
    ds_read_b64_tr_b16 v[196:197], v8 offset:5120
    ds_read_b64_tr_b16 v[198:199], v8 offset:6400
    v_mfma_f32_16x16x32_bf16 v[220:223], v[176:179], v[100:103], v[220:223]
    s_waitcnt lgkmcnt(8)
    v_mfma_f32_16x16x32_bf16 v[224:227], v[180:183], v[96:99], v[224:227]
    ds_read_b64_tr_b16 v[200:201], v8 offset:5152
    ds_read_b64_tr_b16 v[202:203], v8 offset:6432
    v_mfma_f32_16x16x32_bf16 v[228:231], v[180:183], v[100:103], v[228:231]
    buffer_load_dwordx4 v[64:67], v13, s[20:23], s57 offen offset:0 sc1
    buffer_load_dwordx4 v[68:71], v13, s[20:23], s57 offen offset:1024 sc1
    s_waitcnt lgkmcnt(8)
    v_mfma_f32_16x16x32_bf16 v[232:235], v[184:187], v[96:99], v[232:235]
    ds_read_b64_tr_b16 v[204:205], v8 offset:5184
    ds_read_b64_tr_b16 v[206:207], v8 offset:6464
    v_mfma_f32_16x16x32_bf16 v[236:239], v[184:187], v[100:103], v[236:239]
    s_waitcnt lgkmcnt(8)
    v_mfma_f32_16x16x32_bf16 v[240:243], v[188:191], v[96:99], v[240:243]
    ds_read_b64_tr_b16 v[208:209], v8 offset:5216
    ds_read_b64_tr_b16 v[210:211], v8 offset:6496
    v_mfma_f32_16x16x32_bf16 v[244:247], v[188:191], v[100:103], v[244:247]
    s_waitcnt lgkmcnt(8)
    v_mfma_f32_16x16x32_bf16 v[248:251], v[192:195], v[96:99], v[248:251]
    ds_read_b64_tr_b16 v[212:213], v8 offset:5248
    ds_read_b64_tr_b16 v[214:215], v8 offset:6528
    v_mfma_f32_16x16x32_bf16 v[252:255], v[192:195], v[100:103], v[252:255]
    s_waitcnt lgkmcnt(8)
    v_mfma_f32_16x16x32_bf16 v[216:219], v[196:199], v[104:107], v[216:219]
    ds_read_b64_tr_b16 v[176:177], v8 offset:10240
    ds_read_b64_tr_b16 v[178:179], v8 offset:11520
    v_mfma_f32_16x16x32_bf16 v[220:223], v[196:199], v[108:111], v[220:223]
    s_waitcnt lgkmcnt(8)
    v_mfma_f32_16x16x32_bf16 v[224:227], v[200:203], v[104:107], v[224:227]
    ds_read_b64_tr_b16 v[180:181], v8 offset:10272
    ds_read_b64_tr_b16 v[182:183], v8 offset:11552
    v_mfma_f32_16x16x32_bf16 v[228:231], v[200:203], v[108:111], v[228:231]
    s_add_u32 s50, s57, 2048
    buffer_load_dwordx4 v[72:75], v13, s[20:23], s50 offen offset:0 sc1
    buffer_load_dwordx4 v[76:79], v13, s[20:23], s50 offen offset:1024 sc1
    s_waitcnt lgkmcnt(8)
    v_mfma_f32_16x16x32_bf16 v[232:235], v[204:207], v[104:107], v[232:235]
    ds_read_b64_tr_b16 v[184:185], v8 offset:10304
    ds_read_b64_tr_b16 v[186:187], v8 offset:11584
    v_mfma_f32_16x16x32_bf16 v[236:239], v[204:207], v[108:111], v[236:239]
    s_waitcnt lgkmcnt(8)
    v_mfma_f32_16x16x32_bf16 v[240:243], v[208:211], v[104:107], v[240:243]
    ds_read_b64_tr_b16 v[188:189], v8 offset:10336
    ds_read_b64_tr_b16 v[190:191], v8 offset:11616
    v_mfma_f32_16x16x32_bf16 v[244:247], v[208:211], v[108:111], v[244:247]
    s_waitcnt lgkmcnt(8)
    v_mfma_f32_16x16x32_bf16 v[248:251], v[212:215], v[104:107], v[248:251]
    ds_read_b64_tr_b16 v[192:193], v8 offset:10368
    ds_read_b64_tr_b16 v[194:195], v8 offset:11648
    v_mfma_f32_16x16x32_bf16 v[252:255], v[212:215], v[108:111], v[252:255]
    s_waitcnt lgkmcnt(8)
    v_mfma_f32_16x16x32_bf16 v[216:219], v[176:179], v[112:115], v[216:219]
    ds_read_b64_tr_b16 v[196:197], v8 offset:15360
    ds_read_b64_tr_b16 v[198:199], v8 offset:16640
    v_mfma_f32_16x16x32_bf16 v[220:223], v[176:179], v[116:119], v[220:223]
    s_waitcnt lgkmcnt(8)
    v_mfma_f32_16x16x32_bf16 v[224:227], v[180:183], v[112:115], v[224:227]
    ds_read_b64_tr_b16 v[200:201], v8 offset:15392
    ds_read_b64_tr_b16 v[202:203], v8 offset:16672
    v_mfma_f32_16x16x32_bf16 v[228:231], v[180:183], v[116:119], v[228:231]
    s_add_u32 s50, s57, 4096
    buffer_load_dwordx4 v[80:83], v13, s[20:23], s50 offen offset:0 sc1
    buffer_load_dwordx4 v[84:87], v13, s[20:23], s50 offen offset:1024 sc1
    s_waitcnt lgkmcnt(8)
    v_mfma_f32_16x16x32_bf16 v[232:235], v[184:187], v[112:115], v[232:235]
    ds_read_b64_tr_b16 v[204:205], v8 offset:15424
    ds_read_b64_tr_b16 v[206:207], v8 offset:16704
    v_mfma_f32_16x16x32_bf16 v[236:239], v[184:187], v[116:119], v[236:239]
    s_waitcnt lgkmcnt(8)
    v_mfma_f32_16x16x32_bf16 v[240:243], v[188:191], v[112:115], v[240:243]
    ds_read_b64_tr_b16 v[208:209], v8 offset:15456
    ds_read_b64_tr_b16 v[210:211], v8 offset:16736
    v_mfma_f32_16x16x32_bf16 v[244:247], v[188:191], v[116:119], v[244:247]
    s_waitcnt lgkmcnt(8)
    v_mfma_f32_16x16x32_bf16 v[248:251], v[192:195], v[112:115], v[248:251]
    ds_read_b64_tr_b16 v[212:213], v8 offset:15488
    ds_read_b64_tr_b16 v[214:215], v8 offset:16768
    v_mfma_f32_16x16x32_bf16 v[252:255], v[192:195], v[116:119], v[252:255]
    s_waitcnt lgkmcnt(8)
    v_mfma_f32_16x16x32_bf16 v[216:219], v[196:199], v[120:123], v[216:219]
    ds_read_b64_tr_b16 v[176:177], v8 offset:20480
    ds_read_b64_tr_b16 v[178:179], v8 offset:21760
    v_mfma_f32_16x16x32_bf16 v[220:223], v[196:199], v[124:127], v[220:223]
    s_waitcnt lgkmcnt(8)
    v_mfma_f32_16x16x32_bf16 v[224:227], v[200:203], v[120:123], v[224:227]
    ds_read_b64_tr_b16 v[180:181], v8 offset:20512
    ds_read_b64_tr_b16 v[182:183], v8 offset:21792
    v_mfma_f32_16x16x32_bf16 v[228:231], v[200:203], v[124:127], v[228:231]
    s_add_u32 s50, s57, 6144
    buffer_load_dwordx4 v[88:91], v13, s[20:23], s50 offen offset:0 sc1
    buffer_load_dwordx4 v[92:95], v13, s[20:23], s50 offen offset:1024 sc1
    s_waitcnt lgkmcnt(8)
    v_mfma_f32_16x16x32_bf16 v[232:235], v[204:207], v[120:123], v[232:235]
    ds_read_b64_tr_b16 v[184:185], v8 offset:20544
    ds_read_b64_tr_b16 v[186:187], v8 offset:21824
    v_mfma_f32_16x16x32_bf16 v[236:239], v[204:207], v[124:127], v[236:239]
    s_waitcnt lgkmcnt(8)
    v_mfma_f32_16x16x32_bf16 v[240:243], v[208:211], v[120:123], v[240:243]
    ds_read_b64_tr_b16 v[188:189], v8 offset:20576
    ds_read_b64_tr_b16 v[190:191], v8 offset:21856
    v_mfma_f32_16x16x32_bf16 v[244:247], v[208:211], v[124:127], v[244:247]
    s_waitcnt lgkmcnt(8)
    v_mfma_f32_16x16x32_bf16 v[248:251], v[212:215], v[120:123], v[248:251]
    ds_read_b64_tr_b16 v[192:193], v8 offset:20608
    ds_read_b64_tr_b16 v[194:195], v8 offset:21888
    v_mfma_f32_16x16x32_bf16 v[252:255], v[212:215], v[124:127], v[252:255]
    s_waitcnt vmcnt(8)
    s_add_u32 s3, s47, 7
    s_and_b32 s3, s3, 7
    s_lshl_b32 s50, s48, 3
    s_add_u32 s3, s3, s50
    s_lshl_b32 s3, s3, 13
    s_add_u32 s57, s55, s3
    s_waitcnt lgkmcnt(8)
    v_mfma_f32_16x16x32_bf16 v[216:219], v[176:179], v[128:131], v[216:219]
    ds_read_b64_tr_b16 v[196:197], v8 offset:25600
    ds_read_b64_tr_b16 v[198:199], v8 offset:26880
    v_mfma_f32_16x16x32_bf16 v[220:223], v[176:179], v[132:135], v[220:223]
    s_waitcnt lgkmcnt(8)
    v_mfma_f32_16x16x32_bf16 v[224:227], v[180:183], v[128:131], v[224:227]
    ds_read_b64_tr_b16 v[200:201], v8 offset:25632
    ds_read_b64_tr_b16 v[202:203], v8 offset:26912
    v_mfma_f32_16x16x32_bf16 v[228:231], v[180:183], v[132:135], v[228:231]
    buffer_load_dwordx4 v[96:99], v13, s[20:23], s57 offen offset:0 sc1
    buffer_load_dwordx4 v[100:103], v13, s[20:23], s57 offen offset:1024 sc1
    s_waitcnt lgkmcnt(8)
    v_mfma_f32_16x16x32_bf16 v[232:235], v[184:187], v[128:131], v[232:235]
    ds_read_b64_tr_b16 v[204:205], v8 offset:25664
    ds_read_b64_tr_b16 v[206:207], v8 offset:26944
    v_mfma_f32_16x16x32_bf16 v[236:239], v[184:187], v[132:135], v[236:239]
    s_waitcnt lgkmcnt(8)
    v_mfma_f32_16x16x32_bf16 v[240:243], v[188:191], v[128:131], v[240:243]
    ds_read_b64_tr_b16 v[208:209], v8 offset:25696
    ds_read_b64_tr_b16 v[210:211], v8 offset:26976
    v_mfma_f32_16x16x32_bf16 v[244:247], v[188:191], v[132:135], v[244:247]
    s_waitcnt lgkmcnt(8)
    v_mfma_f32_16x16x32_bf16 v[248:251], v[192:195], v[128:131], v[248:251]
    ds_read_b64_tr_b16 v[212:213], v8 offset:25728
    ds_read_b64_tr_b16 v[214:215], v8 offset:27008
    v_mfma_f32_16x16x32_bf16 v[252:255], v[192:195], v[132:135], v[252:255]
    s_waitcnt lgkmcnt(8)
    v_mfma_f32_16x16x32_bf16 v[216:219], v[196:199], v[136:139], v[216:219]
    ds_read_b64_tr_b16 v[176:177], v8 offset:30720
    ds_read_b64_tr_b16 v[178:179], v8 offset:32000
    v_mfma_f32_16x16x32_bf16 v[220:223], v[196:199], v[140:143], v[220:223]
    s_waitcnt lgkmcnt(8)
    v_mfma_f32_16x16x32_bf16 v[224:227], v[200:203], v[136:139], v[224:227]
    ds_read_b64_tr_b16 v[180:181], v8 offset:30752
    ds_read_b64_tr_b16 v[182:183], v8 offset:32032
    v_mfma_f32_16x16x32_bf16 v[228:231], v[200:203], v[140:143], v[228:231]
    s_add_u32 s50, s57, 2048
    buffer_load_dwordx4 v[104:107], v13, s[20:23], s50 offen offset:0 sc1
    buffer_load_dwordx4 v[108:111], v13, s[20:23], s50 offen offset:1024 sc1
    s_waitcnt lgkmcnt(8)
    v_mfma_f32_16x16x32_bf16 v[232:235], v[204:207], v[136:139], v[232:235]
    ds_read_b64_tr_b16 v[184:185], v8 offset:30784
    ds_read_b64_tr_b16 v[186:187], v8 offset:32064
    v_mfma_f32_16x16x32_bf16 v[236:239], v[204:207], v[140:143], v[236:239]
    s_waitcnt lgkmcnt(8)
    v_mfma_f32_16x16x32_bf16 v[240:243], v[208:211], v[136:139], v[240:243]
    ds_read_b64_tr_b16 v[188:189], v8 offset:30816
    ds_read_b64_tr_b16 v[190:191], v8 offset:32096
    v_mfma_f32_16x16x32_bf16 v[244:247], v[208:211], v[140:143], v[244:247]
    s_waitcnt lgkmcnt(8)
    v_mfma_f32_16x16x32_bf16 v[248:251], v[212:215], v[136:139], v[248:251]
    ds_read_b64_tr_b16 v[192:193], v8 offset:30848
    ds_read_b64_tr_b16 v[194:195], v8 offset:32128
    v_mfma_f32_16x16x32_bf16 v[252:255], v[212:215], v[140:143], v[252:255]
    s_waitcnt lgkmcnt(8)
    v_mfma_f32_16x16x32_bf16 v[216:219], v[176:179], v[144:147], v[216:219]
    ds_read_b64_tr_b16 v[196:197], v8 offset:35840
    ds_read_b64_tr_b16 v[198:199], v8 offset:37120
    v_mfma_f32_16x16x32_bf16 v[220:223], v[176:179], v[148:151], v[220:223]
    s_waitcnt lgkmcnt(8)
    v_mfma_f32_16x16x32_bf16 v[224:227], v[180:183], v[144:147], v[224:227]
    ds_read_b64_tr_b16 v[200:201], v8 offset:35872
    ds_read_b64_tr_b16 v[202:203], v8 offset:37152
    v_mfma_f32_16x16x32_bf16 v[228:231], v[180:183], v[148:151], v[228:231]
    s_add_u32 s50, s57, 4096
    buffer_load_dwordx4 v[112:115], v13, s[20:23], s50 offen offset:0 sc1
    buffer_load_dwordx4 v[116:119], v13, s[20:23], s50 offen offset:1024 sc1
    s_waitcnt lgkmcnt(8)
    v_mfma_f32_16x16x32_bf16 v[232:235], v[184:187], v[144:147], v[232:235]
    ds_read_b64_tr_b16 v[204:205], v8 offset:35904
    ds_read_b64_tr_b16 v[206:207], v8 offset:37184
    v_mfma_f32_16x16x32_bf16 v[236:239], v[184:187], v[148:151], v[236:239]
    s_waitcnt lgkmcnt(8)
    v_mfma_f32_16x16x32_bf16 v[240:243], v[188:191], v[144:147], v[240:243]
    ds_read_b64_tr_b16 v[208:209], v8 offset:35936
    ds_read_b64_tr_b16 v[210:211], v8 offset:37216
    v_mfma_f32_16x16x32_bf16 v[244:247], v[188:191], v[148:151], v[244:247]
    s_waitcnt lgkmcnt(8)
    v_mfma_f32_16x16x32_bf16 v[248:251], v[192:195], v[144:147], v[248:251]
    ds_read_b64_tr_b16 v[212:213], v8 offset:35968
    ds_read_b64_tr_b16 v[214:215], v8 offset:37248
    v_mfma_f32_16x16x32_bf16 v[252:255], v[192:195], v[148:151], v[252:255]
    v_add_u32 v8, 40960, v8
    s_waitcnt lgkmcnt(8)
    v_mfma_f32_16x16x32_bf16 v[216:219], v[196:199], v[152:155], v[216:219]
    ds_read_b64_tr_b16 v[176:177], v8 offset:0
    ds_read_b64_tr_b16 v[178:179], v8 offset:1280
    v_mfma_f32_16x16x32_bf16 v[220:223], v[196:199], v[156:159], v[220:223]
    s_waitcnt lgkmcnt(8)
    v_mfma_f32_16x16x32_bf16 v[224:227], v[200:203], v[152:155], v[224:227]
    ds_read_b64_tr_b16 v[180:181], v8 offset:32
    ds_read_b64_tr_b16 v[182:183], v8 offset:1312
    v_mfma_f32_16x16x32_bf16 v[228:231], v[200:203], v[156:159], v[228:231]
    s_add_u32 s50, s57, 6144
    buffer_load_dwordx4 v[120:123], v13, s[20:23], s50 offen offset:0 sc1
    buffer_load_dwordx4 v[124:127], v13, s[20:23], s50 offen offset:1024 sc1
    s_waitcnt lgkmcnt(8)
    v_mfma_f32_16x16x32_bf16 v[232:235], v[204:207], v[152:155], v[232:235]
    ds_read_b64_tr_b16 v[184:185], v8 offset:64
    ds_read_b64_tr_b16 v[186:187], v8 offset:1344
    v_mfma_f32_16x16x32_bf16 v[236:239], v[204:207], v[156:159], v[236:239]
    s_waitcnt lgkmcnt(8)
    v_mfma_f32_16x16x32_bf16 v[240:243], v[208:211], v[152:155], v[240:243]
    ds_read_b64_tr_b16 v[188:189], v8 offset:96
    ds_read_b64_tr_b16 v[190:191], v8 offset:1376
    v_mfma_f32_16x16x32_bf16 v[244:247], v[208:211], v[156:159], v[244:247]
    s_waitcnt lgkmcnt(8)
    v_mfma_f32_16x16x32_bf16 v[248:251], v[212:215], v[152:155], v[248:251]
    ds_read_b64_tr_b16 v[192:193], v8 offset:128
    ds_read_b64_tr_b16 v[194:195], v8 offset:1408
    v_mfma_f32_16x16x32_bf16 v[252:255], v[212:215], v[156:159], v[252:255]
    s_waitcnt vmcnt(8)
    s_waitcnt lgkmcnt(8)
    v_mfma_f32_16x16x32_bf16 v[216:219], v[176:179], v[64:67], v[216:219]
    ds_read_b64_tr_b16 v[196:197], v8 offset:5120
    ds_read_b64_tr_b16 v[198:199], v8 offset:6400
    v_mfma_f32_16x16x32_bf16 v[220:223], v[176:179], v[68:71], v[220:223]
    s_waitcnt lgkmcnt(8)
    v_mfma_f32_16x16x32_bf16 v[224:227], v[180:183], v[64:67], v[224:227]
    ds_read_b64_tr_b16 v[200:201], v8 offset:5152
    ds_read_b64_tr_b16 v[202:203], v8 offset:6432
    v_mfma_f32_16x16x32_bf16 v[228:231], v[180:183], v[68:71], v[228:231]
    s_waitcnt lgkmcnt(8)
    v_mfma_f32_16x16x32_bf16 v[232:235], v[184:187], v[64:67], v[232:235]
    ds_read_b64_tr_b16 v[204:205], v8 offset:5184
    ds_read_b64_tr_b16 v[206:207], v8 offset:6464
    v_mfma_f32_16x16x32_bf16 v[236:239], v[184:187], v[68:71], v[236:239]
    s_waitcnt lgkmcnt(8)
    v_mfma_f32_16x16x32_bf16 v[240:243], v[188:191], v[64:67], v[240:243]
    ds_read_b64_tr_b16 v[208:209], v8 offset:5216
    ds_read_b64_tr_b16 v[210:211], v8 offset:6496
    v_mfma_f32_16x16x32_bf16 v[244:247], v[188:191], v[68:71], v[244:247]
    s_waitcnt lgkmcnt(8)
    v_mfma_f32_16x16x32_bf16 v[248:251], v[192:195], v[64:67], v[248:251]
    ds_read_b64_tr_b16 v[212:213], v8 offset:5248
    ds_read_b64_tr_b16 v[214:215], v8 offset:6528
    v_mfma_f32_16x16x32_bf16 v[252:255], v[192:195], v[68:71], v[252:255]
    s_waitcnt lgkmcnt(8)
    v_mfma_f32_16x16x32_bf16 v[216:219], v[196:199], v[72:75], v[216:219]
    ds_read_b64_tr_b16 v[176:177], v8 offset:10240
    ds_read_b64_tr_b16 v[178:179], v8 offset:11520
    v_mfma_f32_16x16x32_bf16 v[220:223], v[196:199], v[76:79], v[220:223]
    s_waitcnt lgkmcnt(8)
    v_mfma_f32_16x16x32_bf16 v[224:227], v[200:203], v[72:75], v[224:227]
    ds_read_b64_tr_b16 v[180:181], v8 offset:10272
    ds_read_b64_tr_b16 v[182:183], v8 offset:11552
    v_mfma_f32_16x16x32_bf16 v[228:231], v[200:203], v[76:79], v[228:231]
    s_waitcnt lgkmcnt(8)
    v_mfma_f32_16x16x32_bf16 v[232:235], v[204:207], v[72:75], v[232:235]
    ds_read_b64_tr_b16 v[184:185], v8 offset:10304
    ds_read_b64_tr_b16 v[186:187], v8 offset:11584
    v_mfma_f32_16x16x32_bf16 v[236:239], v[204:207], v[76:79], v[236:239]
    s_waitcnt lgkmcnt(8)
    v_mfma_f32_16x16x32_bf16 v[240:243], v[208:211], v[72:75], v[240:243]
    ds_read_b64_tr_b16 v[188:189], v8 offset:10336
    ds_read_b64_tr_b16 v[190:191], v8 offset:11616
    v_mfma_f32_16x16x32_bf16 v[244:247], v[208:211], v[76:79], v[244:247]
    s_waitcnt lgkmcnt(8)
    v_mfma_f32_16x16x32_bf16 v[248:251], v[212:215], v[72:75], v[248:251]
    ds_read_b64_tr_b16 v[192:193], v8 offset:10368
    ds_read_b64_tr_b16 v[194:195], v8 offset:11648
    v_mfma_f32_16x16x32_bf16 v[252:255], v[212:215], v[76:79], v[252:255]
    s_waitcnt lgkmcnt(8)
    v_mfma_f32_16x16x32_bf16 v[216:219], v[176:179], v[80:83], v[216:219]
    ds_read_b64_tr_b16 v[196:197], v8 offset:15360
    ds_read_b64_tr_b16 v[198:199], v8 offset:16640
    v_mfma_f32_16x16x32_bf16 v[220:223], v[176:179], v[84:87], v[220:223]
    s_waitcnt lgkmcnt(8)
    v_mfma_f32_16x16x32_bf16 v[224:227], v[180:183], v[80:83], v[224:227]
    ds_read_b64_tr_b16 v[200:201], v8 offset:15392
    ds_read_b64_tr_b16 v[202:203], v8 offset:16672
    v_mfma_f32_16x16x32_bf16 v[228:231], v[180:183], v[84:87], v[228:231]
    s_waitcnt lgkmcnt(8)
    v_mfma_f32_16x16x32_bf16 v[232:235], v[184:187], v[80:83], v[232:235]
    ds_read_b64_tr_b16 v[204:205], v8 offset:15424
    ds_read_b64_tr_b16 v[206:207], v8 offset:16704
    v_mfma_f32_16x16x32_bf16 v[236:239], v[184:187], v[84:87], v[236:239]
    s_waitcnt lgkmcnt(8)
    v_mfma_f32_16x16x32_bf16 v[240:243], v[188:191], v[80:83], v[240:243]
    ds_read_b64_tr_b16 v[208:209], v8 offset:15456
    ds_read_b64_tr_b16 v[210:211], v8 offset:16736
    v_mfma_f32_16x16x32_bf16 v[244:247], v[188:191], v[84:87], v[244:247]
    s_waitcnt lgkmcnt(8)
    v_mfma_f32_16x16x32_bf16 v[248:251], v[192:195], v[80:83], v[248:251]
    ds_read_b64_tr_b16 v[212:213], v8 offset:15488
    ds_read_b64_tr_b16 v[214:215], v8 offset:16768
    v_mfma_f32_16x16x32_bf16 v[252:255], v[192:195], v[84:87], v[252:255]
    s_waitcnt lgkmcnt(8)
    v_mfma_f32_16x16x32_bf16 v[216:219], v[196:199], v[88:91], v[216:219]
    ds_read_b64_tr_b16 v[176:177], v8 offset:20480
    ds_read_b64_tr_b16 v[178:179], v8 offset:21760
    v_mfma_f32_16x16x32_bf16 v[220:223], v[196:199], v[92:95], v[220:223]
    s_waitcnt lgkmcnt(8)
    v_mfma_f32_16x16x32_bf16 v[224:227], v[200:203], v[88:91], v[224:227]
    ds_read_b64_tr_b16 v[180:181], v8 offset:25600
    ds_read_b64_tr_b16 v[182:183], v8 offset:26880
    v_mfma_f32_16x16x32_bf16 v[228:231], v[200:203], v[92:95], v[228:231]
    s_waitcnt lgkmcnt(8)
    v_mfma_f32_16x16x32_bf16 v[232:235], v[204:207], v[88:91], v[232:235]
    ds_read_b64_tr_b16 v[184:185], v8 offset:30720
    ds_read_b64_tr_b16 v[186:187], v8 offset:32000
    v_mfma_f32_16x16x32_bf16 v[236:239], v[204:207], v[92:95], v[236:239]
    s_waitcnt lgkmcnt(8)
    v_mfma_f32_16x16x32_bf16 v[240:243], v[208:211], v[88:91], v[240:243]
    ds_read_b64_tr_b16 v[188:189], v8 offset:35840
    ds_read_b64_tr_b16 v[190:191], v8 offset:37120
    v_mfma_f32_16x16x32_bf16 v[244:247], v[208:211], v[92:95], v[244:247]
    s_waitcnt lgkmcnt(8)
    v_mfma_f32_16x16x32_bf16 v[248:251], v[212:215], v[88:91], v[248:251]
    v_mfma_f32_16x16x32_bf16 v[252:255], v[212:215], v[92:95], v[252:255]
    s_waitcnt vmcnt(0)
    s_lshl_b32 s50, s46, 3
    s_add_u32 s50, s50, s47
    s_lshl_b32 s50, s50, 2
    s_add_u32 s50, s50, s44
    s_lshl_b32 s56, s50, 7
    s_add_u32 s56, s56, 18890752
    s_mul_i32 s55, s50, 40960
    s_add_u32 s55, s55, 8388608
    s_mul_i32 s3, s48, 10240
    s_add_u32 s50, s55, s3
    s_add_u32 s51, s50, 4096
    s_add_u32 s52, s50, 8192
    s_mov_b32 s32, s18
    s_mov_b32 s33, s19
    s_cmp_eq_u32 s44, s48
    s_cselect_b32 s34, 0, 18939904
    s_mov_b32 s35, 0x20000
    s_waitcnt lgkmcnt(6)
    v_mfma_f32_16x16x32_bf16 v[216:219], v[176:179], v[96:99], v[216:219]
    ds_read_b64_tr_b16 v[196:197], v8 offset:20512
    v_mfma_f32_16x16x32_bf16 v[220:223], v[176:179], v[100:103], v[220:223]
    ds_read_b64_tr_b16 v[198:199], v8 offset:21792
    s_waitcnt lgkmcnt(6)
    v_mfma_f32_16x16x32_bf16 v[216:219], v[180:183], v[104:107], v[216:219]
    ds_read_b64_tr_b16 v[200:201], v8 offset:25632
    v_mfma_f32_16x16x32_bf16 v[220:223], v[180:183], v[108:111], v[220:223]
    ds_read_b64_tr_b16 v[202:203], v8 offset:26912
    s_waitcnt lgkmcnt(6)
    v_mfma_f32_16x16x32_bf16 v[216:219], v[184:187], v[112:115], v[216:219]
    ds_read_b64_tr_b16 v[204:205], v8 offset:30752
    v_mfma_f32_16x16x32_bf16 v[220:223], v[184:187], v[116:119], v[220:223]
    ds_read_b64_tr_b16 v[206:207], v8 offset:32032
    s_waitcnt lgkmcnt(6)
    v_mfma_f32_16x16x32_bf16 v[216:219], v[188:191], v[120:123], v[216:219]
    ds_read_b64_tr_b16 v[208:209], v8 offset:35872
    v_mfma_f32_16x16x32_bf16 v[220:223], v[188:191], v[124:127], v[220:223]
    ds_read_b64_tr_b16 v[210:211], v8 offset:37152
    s_waitcnt lgkmcnt(6)
    v_mfma_f32_16x16x32_bf16 v[224:227], v[196:199], v[96:99], v[224:227]
    ds_read_b64_tr_b16 v[176:177], v8 offset:20544
    v_mfma_f32_16x16x32_bf16 v[228:231], v[196:199], v[100:103], v[228:231]
    ds_read_b64_tr_b16 v[178:179], v8 offset:21824
    s_waitcnt lgkmcnt(6)
    v_mfma_f32_16x16x32_bf16 v[224:227], v[200:203], v[104:107], v[224:227]
    ds_read_b64_tr_b16 v[180:181], v8 offset:25664
    v_mfma_f32_16x16x32_bf16 v[228:231], v[200:203], v[108:111], v[228:231]
    ds_read_b64_tr_b16 v[182:183], v8 offset:26944
    s_waitcnt lgkmcnt(6)
    v_mfma_f32_16x16x32_bf16 v[224:227], v[204:207], v[112:115], v[224:227]
    ds_read_b64_tr_b16 v[184:185], v8 offset:30784
    v_mfma_f32_16x16x32_bf16 v[228:231], v[204:207], v[116:119], v[228:231]
    ds_read_b64_tr_b16 v[186:187], v8 offset:32064
    s_waitcnt lgkmcnt(6)
    v_mfma_f32_16x16x32_bf16 v[224:227], v[208:211], v[120:123], v[224:227]
    ds_read_b64_tr_b16 v[188:189], v8 offset:35904
    v_mfma_f32_16x16x32_bf16 v[228:231], v[208:211], v[124:127], v[228:231]
    ds_read_b64_tr_b16 v[190:191], v8 offset:37184
    buffer_store_dwordx4 v[216:219], v13, s[32:35], s50 offen offset:0 sc1
    buffer_store_dwordx4 v[220:223], v13, s[32:35], s50 offen offset:1024 sc1
    s_waitcnt lgkmcnt(6)
    v_mfma_f32_16x16x32_bf16 v[232:235], v[176:179], v[96:99], v[232:235]
    ds_read_b64_tr_b16 v[196:197], v8 offset:20576
    v_mfma_f32_16x16x32_bf16 v[236:239], v[176:179], v[100:103], v[236:239]
    ds_read_b64_tr_b16 v[198:199], v8 offset:21856
    s_waitcnt lgkmcnt(6)
    v_mfma_f32_16x16x32_bf16 v[232:235], v[180:183], v[104:107], v[232:235]
    ds_read_b64_tr_b16 v[200:201], v8 offset:25696
    v_mfma_f32_16x16x32_bf16 v[236:239], v[180:183], v[108:111], v[236:239]
    ds_read_b64_tr_b16 v[202:203], v8 offset:26976
    s_waitcnt lgkmcnt(6)
    v_mfma_f32_16x16x32_bf16 v[232:235], v[184:187], v[112:115], v[232:235]
    ds_read_b64_tr_b16 v[204:205], v8 offset:30816
    v_mfma_f32_16x16x32_bf16 v[236:239], v[184:187], v[116:119], v[236:239]
    ds_read_b64_tr_b16 v[206:207], v8 offset:32096
    s_waitcnt lgkmcnt(6)
    v_mfma_f32_16x16x32_bf16 v[232:235], v[188:191], v[120:123], v[232:235]
    ds_read_b64_tr_b16 v[208:209], v8 offset:35936
    v_mfma_f32_16x16x32_bf16 v[236:239], v[188:191], v[124:127], v[236:239]
    ds_read_b64_tr_b16 v[210:211], v8 offset:37216
    buffer_store_dwordx4 v[224:227], v13, s[32:35], s50 offen offset:2048 sc1
    buffer_store_dwordx4 v[228:231], v13, s[32:35], s50 offen offset:3072 sc1
    s_waitcnt lgkmcnt(6)
    v_mfma_f32_16x16x32_bf16 v[240:243], v[196:199], v[96:99], v[240:243]
    ds_read_b64_tr_b16 v[176:177], v8 offset:20608
    v_mfma_f32_16x16x32_bf16 v[244:247], v[196:199], v[100:103], v[244:247]
    ds_read_b64_tr_b16 v[178:179], v8 offset:21888
    s_waitcnt lgkmcnt(6)
    v_mfma_f32_16x16x32_bf16 v[240:243], v[200:203], v[104:107], v[240:243]
    ds_read_b64_tr_b16 v[180:181], v8 offset:25728
    v_mfma_f32_16x16x32_bf16 v[244:247], v[200:203], v[108:111], v[244:247]
    ds_read_b64_tr_b16 v[182:183], v8 offset:27008
    s_waitcnt lgkmcnt(6)
    v_mfma_f32_16x16x32_bf16 v[240:243], v[204:207], v[112:115], v[240:243]
    ds_read_b64_tr_b16 v[184:185], v8 offset:30848
    v_mfma_f32_16x16x32_bf16 v[244:247], v[204:207], v[116:119], v[244:247]
    ds_read_b64_tr_b16 v[186:187], v8 offset:32128
    s_waitcnt lgkmcnt(6)
    v_mfma_f32_16x16x32_bf16 v[240:243], v[208:211], v[120:123], v[240:243]
    ds_read_b64_tr_b16 v[188:189], v8 offset:35968
    v_mfma_f32_16x16x32_bf16 v[244:247], v[208:211], v[124:127], v[244:247]
    ds_read_b64_tr_b16 v[190:191], v8 offset:37248
    buffer_store_dwordx4 v[232:235], v13, s[32:35], s51 offen offset:0 sc1
    buffer_store_dwordx4 v[236:239], v13, s[32:35], s51 offen offset:1024 sc1
    s_waitcnt lgkmcnt(6)
    v_mfma_f32_16x16x32_bf16 v[248:251], v[176:179], v[96:99], v[248:251]
    v_mfma_f32_16x16x32_bf16 v[252:255], v[176:179], v[100:103], v[252:255]
    s_waitcnt lgkmcnt(4)
    v_mfma_f32_16x16x32_bf16 v[248:251], v[180:183], v[104:107], v[248:251]
    v_mfma_f32_16x16x32_bf16 v[252:255], v[180:183], v[108:111], v[252:255]
    s_waitcnt lgkmcnt(2)
    v_mfma_f32_16x16x32_bf16 v[248:251], v[184:187], v[112:115], v[248:251]
    v_mfma_f32_16x16x32_bf16 v[252:255], v[184:187], v[116:119], v[252:255]
    s_waitcnt lgkmcnt(0)
    v_mfma_f32_16x16x32_bf16 v[248:251], v[188:191], v[120:123], v[248:251]
    v_mfma_f32_16x16x32_bf16 v[252:255], v[188:191], v[124:127], v[252:255]
    buffer_store_dwordx4 v[240:243], v13, s[32:35], s51 offen offset:2048 sc1
    buffer_store_dwordx4 v[244:247], v13, s[32:35], s51 offen offset:3072 sc1
    s_lshl_b32 s3, s48, 3
    v_mov_b32 v2, s3
    s_nop 5
    buffer_store_dwordx4 v[248:251], v13, s[32:35], s52 offen offset:0 sc1
    buffer_store_dwordx4 v[252:255], v13, s[32:35], s52 offen offset:1024 sc1
    s_cmp_eq_u32 s44, s48
    s_cbranch_scc1 C_OWNER
    s_waitcnt vmcnt(0)
    s_mov_b64 exec, 1
    buffer_store_dwordx2 v[6:7], v2, s[20:23], s56 offen sc1
    s_mov_b64 exec, -1
    s_branch C_END
C_OWNER:
    s_lshl_b32 s51, 1, s48
    s_xor_b32 s51, s51, 0xf
    s_mov_b64 exec, 0xf
    s_mov_b32 s59, 2000000
C_POLL2:
    s_cmp_lt_u32 s59, 1999744
    s_cbranch_scc1 C_POLL2_A
    buffer_load_dwordx2 v[38:39], v14, s[20:23], s56 offen sc1
    s_branch C_POLL2_B
C_POLL2_A:
    v_mov_b32 v38, 0
    v_mov_b32 v39, 0
    buffer_atomic_or_x2 v[38:39], v14, s[20:23], s56 offen sc0 sc1
C_POLL2_B:
    s_waitcnt vmcnt(0)
    v_cmp_eq_u64 vcc, s[86:87], v[38:39]
    s_sub_u32 s59, s59, 1
    s_cbranch_scc1 C_POLL2_X
    s_and_b32 s58, vcc_lo, s51
    s_cmp_eq_u32 s58, s51
    s_cbranch_scc0 C_POLL2
C_POLL2_X:
    s_mov_b64 exec, -1
    s_cmp_ge_u32 0, s48
    s_cselect_b32 s3, 1, 0
    s_mul_i32 s3, s3, 10240
    s_add_u32 s60, s55, s3
    s_cmp_ge_u32 1, s48
    s_cselect_b32 s3, 2, 1
    s_mul_i32 s3, s3, 10240
    s_add_u32 s61, s55, s3
    s_cmp_ge_u32 2, s48
    s_cselect_b32 s3, 3, 2
    s_mul_i32 s3, s3, 10240
    s_add_u32 s62, s55, s3
    buffer_load_dwordx4 v[64:67], v13, s[20:23], s60 offen offset:0 sc1
    buffer_load_dwordx4 v[68:71], v13, s[20:23], s61 offen offset:0 sc1
    buffer_load_dwordx4 v[72:75], v13, s[20:23], s62 offen offset:0 sc1
    buffer_load_dwordx4 v[76:79], v13, s[20:23], s60 offen offset:1024 sc1
    buffer_load_dwordx4 v[80:83], v13, s[20:23], s61 offen offset:1024 sc1
    buffer_load_dwordx4 v[84:87], v13, s[20:23], s62 offen offset:1024 sc1
    buffer_load_dwordx4 v[88:91], v13, s[20:23], s60 offen offset:2048 sc1
    buffer_load_dwordx4 v[92:95], v13, s[20:23], s61 offen offset:2048 sc1
    buffer_load_dwordx4 v[96:99], v13, s[20:23], s62 offen offset:2048 sc1
    buffer_load_dwordx4 v[100:103], v13, s[20:23], s60 offen offset:3072 sc1
    buffer_load_dwordx4 v[104:107], v13, s[20:23], s61 offen offset:3072 sc1
    buffer_load_dwordx4 v[108:111], v13, s[20:23], s62 offen offset:3072 sc1
    s_add_u32 s60, s60, 4096
    buffer_load_dwordx4 v[112:115], v13, s[20:23], s60 offen offset:0 sc1
    s_add_u32 s61, s61, 4096
    buffer_load_dwordx4 v[116:119], v13, s[20:23], s61 offen offset:0 sc1
    s_add_u32 s62, s62, 4096
    buffer_load_dwordx4 v[120:123], v13, s[20:23], s62 offen offset:0 sc1
    buffer_load_dwordx4 v[124:127], v13, s[20:23], s60 offen offset:1024 sc1
    buffer_load_dwordx4 v[128:131], v13, s[20:23], s61 offen offset:1024 sc1
    buffer_load_dwordx4 v[132:135], v13, s[20:23], s62 offen offset:1024 sc1
    buffer_load_dwordx4 v[136:139], v13, s[20:23], s60 offen offset:2048 sc1
    buffer_load_dwordx4 v[140:143], v13, s[20:23], s61 offen offset:2048 sc1
    buffer_load_dwordx4 v[144:147], v13, s[20:23], s62 offen offset:2048 sc1
    buffer_load_dwordx4 v[148:151], v13, s[20:23], s60 offen offset:3072 sc1
    buffer_load_dwordx4 v[152:155], v13, s[20:23], s61 offen offset:3072 sc1
    buffer_load_dwordx4 v[156:159], v13, s[20:23], s62 offen offset:3072 sc1
    s_add_u32 s60, s60, 4096
    buffer_load_dwordx4 v[160:163], v13, s[20:23], s60 offen offset:0 sc1
    s_add_u32 s61, s61, 4096
    buffer_load_dwordx4 v[164:167], v13, s[20:23], s61 offen offset:0 sc1
    s_add_u32 s62, s62, 4096
    buffer_load_dwordx4 v[168:171], v13, s[20:23], s62 offen offset:0 sc1
    buffer_load_dwordx4 v[172:175], v13, s[20:23], s60 offen offset:1024 sc1
    buffer_load_dwordx4 v[176:179], v13, s[20:23], s61 offen offset:1024 sc1
    buffer_load_dwordx4 v[180:183], v13, s[20:23], s62 offen offset:1024 sc1
    s_lshl_b32 s50, s46, 7
    s_lshl_b32 s3, s44, 5
    s_add_u32 s50, s50, s3
    v_add_u32 v2, s50, v35
    s_movk_i32 s51, 1280
    v_mul_u32_u24 v2, s51, v2
    v_lshrrev_b32 v3, 4, v1
    v_lshl_add_u32 v2, v3, 3, v2
    v_add_u32 v4, 20480, v2
    s_mul_i32 s52, s47, 160
    s_waitcnt vmcnt(27)
    v_pk_add_f32 v[216:217], v[216:217], v[64:65]
    v_pk_add_f32 v[218:219], v[218:219], v[66:67]
    v_pk_add_f32 v[216:217], v[216:217], v[68:69]
    v_pk_add_f32 v[218:219], v[218:219], v[70:71]
    v_pk_add_f32 v[216:217], v[216:217], v[72:73]
    v_pk_add_f32 v[218:219], v[218:219], v[74:75]
    v_cvt_pk_bf16_f32 v184, v216, v217
    v_cvt_pk_bf16_f32 v185, v218, v219
    s_add_u32 s50, s52, 0
    buffer_store_dwordx2 v[184:185], v2, s[24:27], s50 offen
    s_waitcnt vmcnt(25)
    v_pk_add_f32 v[220:221], v[220:221], v[76:77]
    v_pk_add_f32 v[222:223], v[222:223], v[78:79]
    v_pk_add_f32 v[220:221], v[220:221], v[80:81]
    v_pk_add_f32 v[222:223], v[222:223], v[82:83]
    v_pk_add_f32 v[220:221], v[220:221], v[84:85]
    v_pk_add_f32 v[222:223], v[222:223], v[86:87]
    v_cvt_pk_bf16_f32 v186, v220, v221
    v_cvt_pk_bf16_f32 v187, v222, v223
    buffer_store_dwordx2 v[186:187], v4, s[24:27], s50 offen
    s_waitcnt vmcnt(23)
    v_pk_add_f32 v[224:225], v[224:225], v[88:89]
    v_pk_add_f32 v[226:227], v[226:227], v[90:91]
    v_pk_add_f32 v[224:225], v[224:225], v[92:93]
    v_pk_add_f32 v[226:227], v[226:227], v[94:95]
    v_pk_add_f32 v[224:225], v[224:225], v[96:97]
    v_pk_add_f32 v[226:227], v[226:227], v[98:99]
    v_cvt_pk_bf16_f32 v188, v224, v225
    v_cvt_pk_bf16_f32 v189, v226, v227
    s_add_u32 s50, s52, 32
    buffer_store_dwordx2 v[188:189], v2, s[24:27], s50 offen
    s_waitcnt vmcnt(21)
    v_pk_add_f32 v[228:229], v[228:229], v[100:101]
    v_pk_add_f32 v[230:231], v[230:231], v[102:103]
    v_pk_add_f32 v[228:229], v[228:229], v[104:105]
    v_pk_add_f32 v[230:231], v[230:231], v[106:107]
    v_pk_add_f32 v[228:229], v[228:229], v[108:109]
    v_pk_add_f32 v[230:231], v[230:231], v[110:111]
    v_cvt_pk_bf16_f32 v190, v228, v229
    v_cvt_pk_bf16_f32 v191, v230, v231
    buffer_store_dwordx2 v[190:191], v4, s[24:27], s50 offen
    s_waitcnt vmcnt(19)
    v_pk_add_f32 v[232:233], v[232:233], v[112:113]
    v_pk_add_f32 v[234:235], v[234:235], v[114:115]
    v_pk_add_f32 v[232:233], v[232:233], v[116:117]
    v_pk_add_f32 v[234:235], v[234:235], v[118:119]
    v_pk_add_f32 v[232:233], v[232:233], v[120:121]
    v_pk_add_f32 v[234:235], v[234:235], v[122:123]
    v_cvt_pk_bf16_f32 v184, v232, v233
    v_cvt_pk_bf16_f32 v185, v234, v235
    s_add_u32 s50, s52, 64
    buffer_store_dwordx2 v[184:185], v2, s[24:27], s50 offen
    s_waitcnt vmcnt(17)
    v_pk_add_f32 v[236:237], v[236:237], v[124:125]
    v_pk_add_f32 v[238:239], v[238:239], v[126:127]
    v_pk_add_f32 v[236:237], v[236:237], v[128:129]
    v_pk_add_f32 v[238:239], v[238:239], v[130:131]
    v_pk_add_f32 v[236:237], v[236:237], v[132:133]
    v_pk_add_f32 v[238:239], v[238:239], v[134:135]
    v_cvt_pk_bf16_f32 v186, v236, v237
    v_cvt_pk_bf16_f32 v187, v238, v239
    buffer_store_dwordx2 v[186:187], v4, s[24:27], s50 offen
    s_waitcnt vmcnt(15)
    v_pk_add_f32 v[240:241], v[240:241], v[136:137]
    v_pk_add_f32 v[242:243], v[242:243], v[138:139]
    v_pk_add_f32 v[240:241], v[240:241], v[140:141]
    v_pk_add_f32 v[242:243], v[242:243], v[142:143]
    v_pk_add_f32 v[240:241], v[240:241], v[144:145]
    v_pk_add_f32 v[242:243], v[242:243], v[146:147]
    v_cvt_pk_bf16_f32 v188, v240, v241
    v_cvt_pk_bf16_f32 v189, v242, v243
    s_add_u32 s50, s52, 96
    buffer_store_dwordx2 v[188:189], v2, s[24:27], s50 offen
    s_waitcnt vmcnt(13)
    v_pk_add_f32 v[244:245], v[244:245], v[148:149]
    v_pk_add_f32 v[246:247], v[246:247], v[150:151]
    v_pk_add_f32 v[244:245], v[244:245], v[152:153]
    v_pk_add_f32 v[246:247], v[246:247], v[154:155]
    v_pk_add_f32 v[244:245], v[244:245], v[156:157]
    v_pk_add_f32 v[246:247], v[246:247], v[158:159]
    v_cvt_pk_bf16_f32 v190, v244, v245
    v_cvt_pk_bf16_f32 v191, v246, v247
    buffer_store_dwordx2 v[190:191], v4, s[24:27], s50 offen
    s_waitcnt vmcnt(11)
    v_pk_add_f32 v[248:249], v[248:249], v[160:161]
    v_pk_add_f32 v[250:251], v[250:251], v[162:163]
    v_pk_add_f32 v[248:249], v[248:249], v[164:165]
    v_pk_add_f32 v[250:251], v[250:251], v[166:167]
    v_pk_add_f32 v[248:249], v[248:249], v[168:169]
    v_pk_add_f32 v[250:251], v[250:251], v[170:171]
    v_cvt_pk_bf16_f32 v184, v248, v249
    v_cvt_pk_bf16_f32 v185, v250, v251
    s_add_u32 s50, s52, 128
    buffer_store_dwordx2 v[184:185], v2, s[24:27], s50 offen
    s_waitcnt vmcnt(9)
    v_pk_add_f32 v[252:253], v[252:253], v[172:173]
    v_pk_add_f32 v[254:255], v[254:255], v[174:175]
    v_pk_add_f32 v[252:253], v[252:253], v[176:177]
    v_pk_add_f32 v[254:255], v[254:255], v[178:179]
    v_pk_add_f32 v[252:253], v[252:253], v[180:181]
    v_pk_add_f32 v[254:255], v[254:255], v[182:183]
    v_cvt_pk_bf16_f32 v186, v252, v253
    v_cvt_pk_bf16_f32 v187, v254, v255
    buffer_store_dwordx2 v[186:187], v4, s[24:27], s50 offen
C_END:
    s_endpgm
K_CODE_END:
.section .rodata,"a"
.p2align 6
.amdhsa_kernel standalone__gqa_block_cached__near_ridge_kernel
  .amdhsa_next_free_vgpr 256
  .amdhsa_next_free_sgpr 102
  .amdhsa_accum_offset 256
  .amdhsa_group_segment_fixed_size 0
  .amdhsa_kernarg_size 64
  .amdhsa_user_sgpr_count 2
  .amdhsa_user_sgpr_kernarg_segment_ptr 1
  .amdhsa_system_sgpr_workgroup_id_x 1
  .amdhsa_float_denorm_mode_32 3
.end_amdhsa_kernel
```
